```python
import torch

def _softmax(x, axis=-1):
    return torch.softmax(x, dim=axis)
def _gelu(x):
    return torch.nn.functional.gelu(x, approximate="tanh")
def _silu(x):
    return torch.nn.functional.silu(x)
def _sigmoid(x):
    return torch.sigmoid(x)
def _layernorm(x, axis=-1, eps=1e-5):
    m = x.mean(dim=axis, keepdim=True)
    v = x.var(dim=axis, keepdim=True, unbiased=False)
    return (x - m) / torch.sqrt(v + eps)
def _scatter_add(tgt, idx, src, axis=0):
    return tgt.clone().index_add_(axis, idx, src)
def _segment_sum(src, seg, n):
    out = torch.zeros((n,) + src.shape[1:], dtype=src.dtype)
    return out.index_add_(0, seg, src)
def _pad(x, pw):
    flat = tuple(v for pair in reversed(pw) for v in pair)
    return torch.nn.functional.pad(x, flat)

kernel_name = 'gated_mix__ssm_conv_s5__dense_activation_relu__prompt'

def setup_inputs():

    _w = (lambda a: (lambda t: t.to(torch.bfloat16) if t.is_floating_point() else t)(torch.as_tensor(a)))
    def _A_setup():
        B, S, D = 1, 2048, 1024
        P = D
        Lambda_re = -0.5 * (lambda _x: torch.exp(torch.as_tensor(_x)))((lambda *s: torch.randn(*s, dtype=torch.bfloat16) * 0.8)(P))
        Lambda_im = (lambda *s: torch.randn(*s, dtype=torch.bfloat16) * 0.8)(P) * 1.0
        B_re = (lambda *s: torch.randn(*s, dtype=torch.bfloat16) * 0.8)(P, D) * (D ** -0.5)
        B_im = (lambda *s: torch.randn(*s, dtype=torch.bfloat16) * 0.8)(P, D) * (D ** -0.5)
        C_re = (lambda *s: torch.randn(*s, dtype=torch.bfloat16) * 0.8)(D, P) * (P ** -0.5)
        C_im = (lambda *s: torch.randn(*s, dtype=torch.bfloat16) * 0.8)(D, P) * (P ** -0.5)
        log_dt = (lambda *s: torch.randn(*s, dtype=torch.bfloat16) * 0.8)(P) * 0.3 - 2.0
        Dskip = (lambda *s: torch.randn(*s, dtype=torch.bfloat16) * 0.8)(D)
        return {
            "x": _w((lambda *s: torch.randn(*s, dtype=torch.bfloat16) * 0.05)(B, S, D)),
            "Lambda_re": _w(Lambda_re),
            "Lambda_im": _w(Lambda_im),
            "B_re": _w(B_re),
            "B_im": _w(B_im),
            "C_re": _w(C_re),
            "C_im": _w(C_im),
            "log_dt": _w(log_dt),
            "Dskip": _w(Dskip),
        }
    _A_in = _A_setup()

    def _B_setup():
        B, S, D, Dff = 1, 2048, 1024, 3584
        return {
            "x": _w((lambda *s: torch.randn(*s, dtype=torch.bfloat16) * 0.05)(B, S, D)),
            "w1": _w((lambda *s: torch.randn(*s, dtype=torch.bfloat16) * 0.05)(D, Dff)),
            "w2": _w((lambda *s: torch.randn(*s, dtype=torch.bfloat16) * 0.05)(Dff, D)),
        }
    _B_in = _B_setup()

    return {
        "A_x": _A_in["x"],
        "A_Lambda_re": _A_in["Lambda_re"],
        "A_Lambda_im": _A_in["Lambda_im"],
        "A_B_re": _A_in["B_re"],
        "A_B_im": _A_in["B_im"],
        "A_C_re": _A_in["C_re"],
        "A_C_im": _A_in["C_im"],
        "A_log_dt": _A_in["log_dt"],
        "A_Dskip": _A_in["Dskip"],
        "B_x": _B_in["x"],
        "B_w1": _B_in["w1"],
        "B_w2": _B_in["w2"],
        "gate_w": _w((lambda *s: torch.randn(*s, dtype=torch.bfloat16) * 0.05)(1024) * 16.0),
    }

def reference(A_x, A_Lambda_re, A_Lambda_im, A_B_re, A_B_im, A_C_re, A_C_im, A_log_dt, A_Dskip, B_x, B_w1, B_w2, gate_w):
    def _A_ref(x, Lambda_re, Lambda_im, B_re, B_im, C_re, C_im, log_dt, Dskip):
        Bsz, L, H = x.shape
        Lam = Lambda_re + 1j * Lambda_im
        Bmat = B_re + 1j * B_im
        Cmat = C_re + 1j * C_im
        dt = torch.exp(log_dt)
        Lam_bar = torch.exp(dt * Lam)
        B_bar = ((Lam_bar - 1.0) / Lam)[:, None] * Bmat
        Bu = torch.einsum("bld,pd->blp", x + 0j, B_bar)
        h = torch.zeros_like(Bu[:, 0, :])
        hs = []
        for t in range(L):
            h = Lam_bar[None, :] * h + Bu[:, t, :]
            hs.append(h)
        hseq = torch.stack(hs, 1)
        y = 2.0 * torch.einsum("blp,dp->bld", hseq, Cmat).real + x * Dskip[None, None, :]
        return y

    def _B_ref(x, w1, w2):
        h = torch.einsum("bsd,df->bsf", x, w1)
        zero = torch.zeros_like(h)
        h = torch.maximum(h, zero)
        return torch.einsum("bsf,fd->bsd", h, w2)

    x = A_x
    g = _sigmoid((x * gate_w).sum(-1, keepdims=True))
    a = _A_ref(x, A_Lambda_re, A_Lambda_im, A_B_re, A_B_im, A_C_re, A_C_im, A_log_dt, A_Dskip)
    b = _B_ref(x, B_w1, B_w2)
    return g * a + (1 - g) * b
```

```asm
; @launch grid=(256,1,1) block=(512,1,1) lds=163840
.amdgcn_target "amdgcn-amd-amdhsa--gfx950"
.text
.globl gated_mix__ssm_conv_s5__dense_activation_relu__prompt_kernel
.p2align 8
.type gated_mix__ssm_conv_s5__dense_activation_relu__prompt_kernel,@function
gated_mix__ssm_conv_s5__dense_activation_relu__prompt_kernel:
    s_cmp_ge_u32 s2, 256
    s_cbranch_scc1 k1_end
    s_load_dwordx4 s[28:31], s[0:1], 0
    s_load_dwordx4 s[32:35], s[0:1], 16
    s_load_dwordx2 s[36:37], s[0:1], 32
    s_load_dwordx2 s[38:39], s[0:1], 56
    s_load_dwordx2 s[40:41], s[0:1], 80
    s_load_dwordx2 s[42:43], s[0:1], 96
    s_load_dwordx4 s[44:47], s[0:1], 112
    s_load_dwordx4 s[88:91], s[0:1], 40
    s_load_dwordx2 s[92:93], s[0:1], 64
    s_load_dwordx2 s[94:95], s[0:1], 88
    s_load_dwordx2 s[86:87], s[0:1], 104
    v_lshrrev_b32 v1, 6, v0
    s_nop 0
    v_readfirstlane_b32 s3, v1
    v_and_b32 v1, 63, v0
    v_and_b32 v2, 15, v1
    v_lshrrev_b32 v3, 4, v1
    s_and_b32 s4, s2, 1
    s_lshl_b32 s4, s4, 2
    s_bfe_u32 s5, s2, 0x20003
    s_add_u32 s4, s4, s5
    s_bfe_u32 s5, s2, 0x20001
    s_lshl_b32 s5, s5, 2
    s_bfe_u32 s6, s2, 0x20005
    s_add_u32 s5, s5, s6
    s_lshr_b32 s6, s3, 1
    s_and_b32 s7, s3, 1
    v_and_b32 v6, 7, v1
    v_xor_b32 v6, v3, v6
    v_lshlrev_b32 v6, 4, v6
    v_lshl_add_u32 v4, v2, 7, v6
    s_lshl_b32 s48, s6, 13
    v_add_u32 v4, s48, v4
    v_xor_b32 v5, 64, v4
    v_lshrrev_b32 v8, 3, v1
    v_and_b32 v7, 7, v1
    v_xor_b32 v7, v7, v8
    v_lshlrev_b32 v7, 4, v7
    v_bfe_u32 v9, v1, 2, 2
    v_and_b32 v10, 3, v1
    s_waitcnt lgkmcnt(0)
    s_mov_b32 s8, s28
    s_and_b32 s9, s29, 0xffff
    s_mov_b32 s10, 0x400000
    s_mov_b32 s11, 0x20000
    s_mov_b32 s12, s40
    s_and_b32 s13, s41, 0xffff
    s_mov_b32 s14, 0x700000
    s_mov_b32 s15, 0x20000
    s_mov_b32 s24, s46
    s_and_b32 s25, s47, 0xffff
    s_mov_b32 s26, 0x10000000
    s_mov_b32 s27, 0x20000
    s_mov_b32 s80, s44
    s_and_b32 s81, s45, 0xffff
    s_mov_b32 s82, 0x100
    s_mov_b32 s83, 0x20000
    v_mov_b32 v31, 0
    s_add_u32 s48, s2, s3
    s_cmp_lg_u32 s48, 0
    s_cbranch_scc1 k1_nononce
    s_memrealtime s[48:49]
    s_waitcnt lgkmcnt(0)
    s_or_b32 s48, s48, 1
    v_mov_b32 v30, s48
    buffer_store_dword v30, v31, s[80:83], 0 offen sc1
k1_nononce:
    s_bitcmp1_b32 s2, 7
    s_cbranch_scc1 k1_ffn
    s_mov_b32 s16, s34
    s_and_b32 s17, s35, 0xffff
    s_mov_b32 s18, 0x200000
    s_mov_b32 s19, 0x20000
    s_and_b32 s48, s37, 0xffff
    s_cmp_ge_u32 s3, 4
    s_cselect_b32 s16, s36, s16
    s_cselect_b32 s17, s48, s17
    s_mov_b32 s64, s30
    s_and_b32 s65, s31, 0xffff
    s_mov_b32 s66, 0x800
    s_mov_b32 s67, 0x20000
    s_mov_b32 s68, s32
    s_and_b32 s69, s33, 0xffff
    s_mov_b32 s70, 0x800
    s_mov_b32 s71, 0x20000
    s_mov_b32 s72, s38
    s_and_b32 s73, s39, 0xffff
    s_mov_b32 s74, 0x800
    s_mov_b32 s75, 0x20000
    s_mov_b32 s76, s42
    s_and_b32 s77, s43, 0xffff
    s_mov_b32 s78, 0x800
    s_mov_b32 s79, 0x20000
    s_lshl_b32 s48, s5, 6
    s_lshl_b32 s49, s7, 5
    s_add_u32 s49, s49, s48
    v_add_u32 v24, s49, v2
    v_lshlrev_b32 v24, 1, v24
    v_add_u32 v25, s48, v1
    v_lshlrev_b32 v25, 1, v25
    buffer_load_ushort v128, v24, s[64:67], 0 offen
    buffer_load_ushort v131, v24, s[64:67], 0 offen offset:32
    buffer_load_ushort v134, v25, s[64:67], 0 offen
    buffer_load_ushort v129, v24, s[68:71], 0 offen
    buffer_load_ushort v132, v24, s[68:71], 0 offen offset:32
    buffer_load_ushort v135, v25, s[68:71], 0 offen
    buffer_load_ushort v130, v24, s[72:75], 0 offen
    buffer_load_ushort v133, v24, s[72:75], 0 offen offset:32
    buffer_load_ushort v136, v25, s[72:75], 0 offen
    s_lshl_b32 s48, s4, 8
    s_lshl_b32 s49, s6, 6
    s_add_u32 s48, s48, s49
    s_lshl_b32 s49, s7, 3
    s_add_u32 s48, s48, s49
    v_lshrrev_b32 v12, 2, v8
    v_lshlrev_b32 v12, 4, v12
    v_and_b32 v13, 3, v8
    v_add3_u32 v12, v12, v13, s48
    v_lshl_add_u32 v12, v12, 11, v7
    v_add_u32 v13, 65536, v12
    v_add_u32 v14, 8192, v12
    v_add_u32 v15, 73728, v12
    s_lshl_b32 s48, s5, 6
    s_and_b32 s49, s3, 3
    s_lshl_b32 s49, s49, 4
    s_add_u32 s48, s48, s49
    v_add_u32 v16, s48, v8
    v_lshl_add_u32 v16, v16, 11, v7
    v_add_u32 v17, 16384, v16
    s_lshl_b32 s52, s3, 12
    s_lshl_b32 s53, s3, 11
    s_add_u32 s53, s53, 32768
    s_mov_b32 s54, 0
    s_mov_b32 s55, 0
    s_mov_b32 s50, 0
    s_mov_b32 s50, 0
    s_add_u32 s51, s50, s52
    s_add_u32 m0, s51, 0
    s_nop 0
    buffer_load_dwordx4 v12, s[8:11], s54 offen lds
    s_add_u32 s51, s50, s52
    s_add_u32 m0, s51, 1024
    s_nop 0
    buffer_load_dwordx4 v13, s[8:11], s54 offen lds
    s_add_u32 s51, s50, s52
    s_add_u32 m0, s51, 2048
    s_nop 0
    buffer_load_dwordx4 v14, s[8:11], s54 offen lds
    s_add_u32 s51, s50, s52
    s_add_u32 m0, s51, 3072
    s_nop 0
    buffer_load_dwordx4 v15, s[8:11], s54 offen lds
    s_add_u32 s51, s50, s53
    s_add_u32 m0, s51, 0
    s_nop 0
    buffer_load_dwordx4 v16, s[16:19], s54 offen lds
    s_add_u32 s51, s50, s53
    s_add_u32 m0, s51, 1024
    s_nop 0
    buffer_load_dwordx4 v17, s[16:19], s54 offen lds
    s_add_u32 s54, s54, 128
    s_mov_b32 s50, 49152
    s_add_u32 s51, s50, s52
    s_add_u32 m0, s51, 0
    s_nop 0
    buffer_load_dwordx4 v12, s[8:11], s54 offen lds
    s_add_u32 s51, s50, s52
    s_add_u32 m0, s51, 1024
    s_nop 0
    buffer_load_dwordx4 v13, s[8:11], s54 offen lds
    s_add_u32 s51, s50, s52
    s_add_u32 m0, s51, 2048
    s_nop 0
    buffer_load_dwordx4 v14, s[8:11], s54 offen lds
    s_add_u32 s51, s50, s52
    s_add_u32 m0, s51, 3072
    s_nop 0
    buffer_load_dwordx4 v15, s[8:11], s54 offen lds
    s_add_u32 s51, s50, s53
    s_add_u32 m0, s51, 0
    s_nop 0
    buffer_load_dwordx4 v16, s[16:19], s54 offen lds
    s_add_u32 s51, s50, s53
    s_add_u32 m0, s51, 1024
    s_nop 0
    buffer_load_dwordx4 v17, s[16:19], s54 offen lds
    s_add_u32 s54, s54, 128
    s_mov_b32 s50, 98304
    s_add_u32 s51, s50, s52
    s_add_u32 m0, s51, 0
    s_nop 0
    buffer_load_dwordx4 v12, s[8:11], s54 offen lds
    s_add_u32 s51, s50, s52
    s_add_u32 m0, s51, 1024
    s_nop 0
    buffer_load_dwordx4 v13, s[8:11], s54 offen lds
    s_add_u32 s51, s50, s52
    s_add_u32 m0, s51, 2048
    s_nop 0
    buffer_load_dwordx4 v14, s[8:11], s54 offen lds
    v_lshl_add_u32 v20, v2, 7, v6
    s_lshl_b32 s48, s7, 12
    s_add_u32 s48, s48, 32768
    v_add_u32 v20, s48, v20
    v_xor_b32 v21, 64, v20
    v_mov_b64 v[32:33], 0
    v_mov_b64 v[34:35], 0
    v_mov_b64 v[36:37], 0
    v_mov_b64 v[38:39], 0
    v_mov_b64 v[40:41], 0
    v_mov_b64 v[42:43], 0
    v_mov_b64 v[44:45], 0
    v_mov_b64 v[46:47], 0
    v_mov_b64 v[48:49], 0
    v_mov_b64 v[50:51], 0
    v_mov_b64 v[52:53], 0
    v_mov_b64 v[54:55], 0
    v_mov_b64 v[56:57], 0
    v_mov_b64 v[58:59], 0
    v_mov_b64 v[60:61], 0
    v_mov_b64 v[62:63], 0
    v_mov_b64 v[64:65], 0
    v_mov_b64 v[66:67], 0
    v_mov_b64 v[68:69], 0
    v_mov_b64 v[70:71], 0
    v_mov_b64 v[72:73], 0
    v_mov_b64 v[74:75], 0
    v_mov_b64 v[76:77], 0
    v_mov_b64 v[78:79], 0
    v_mov_b64 v[80:81], 0
    v_mov_b64 v[82:83], 0
    v_mov_b64 v[84:85], 0
    v_mov_b64 v[86:87], 0
    v_mov_b64 v[88:89], 0
    v_mov_b64 v[90:91], 0
    v_mov_b64 v[92:93], 0
    v_mov_b64 v[94:95], 0
    s_waitcnt vmcnt(15)
    v_lshlrev_b32 v128, 16, v128
    v_lshlrev_b32 v129, 16, v129
    v_lshlrev_b32 v130, 16, v130
    v_mul_f32 v168, 0x3fb8aa3b, v130
    v_exp_f32 v168, v168
    s_nop 0
    v_cvt_pk_bf16_f32 v168, v168, v168
    v_and_b32 v168, 0xffff0000, v168
    v_mul_f32 v169, v168, v128
    v_mul_f32 v170, v168, v129
    v_mul_f32 v169, 0x3fb8aa3b, v169
    v_exp_f32 v169, v169
    v_mul_f32 v170, 0.15915494, v170
    v_rndne_f32 v171, v170
    v_sub_f32 v170, v170, v171
    v_cos_f32 v171, v170
    v_sin_f32 v172, v170
    s_nop 0
    v_mul_f32 v208, v169, v171
    v_mul_f32 v209, v169, v172
    v_add_f32 v168, -1.0, v208
    v_mul_f32 v169, v128, v128
    v_fma_f32 v169, v129, v129, v169
    v_rcp_f32 v169, v169
    v_mul_f32 v170, v168, v128
    v_fma_f32 v170, v209, v129, v170
    v_mul_f32 v171, v209, v128
    v_fma_f32 v171, -v168, v129, v171
    v_mul_f32 v210, v170, v169
    v_mul_f32 v211, v171, v169
    v_lshlrev_b32 v131, 16, v131
    v_lshlrev_b32 v132, 16, v132
    v_lshlrev_b32 v133, 16, v133
    v_mul_f32 v168, 0x3fb8aa3b, v133
    v_exp_f32 v168, v168
    s_nop 0
    v_cvt_pk_bf16_f32 v168, v168, v168
    v_and_b32 v168, 0xffff0000, v168
    v_mul_f32 v169, v168, v131
    v_mul_f32 v170, v168, v132
    v_mul_f32 v169, 0x3fb8aa3b, v169
    v_exp_f32 v169, v169
    v_mul_f32 v170, 0.15915494, v170
    v_rndne_f32 v171, v170
    v_sub_f32 v170, v170, v171
    v_cos_f32 v171, v170
    v_sin_f32 v172, v170
    s_nop 0
    v_mul_f32 v212, v169, v171
    v_mul_f32 v213, v169, v172
    v_add_f32 v168, -1.0, v212
    v_mul_f32 v169, v131, v131
    v_fma_f32 v169, v132, v132, v169
    v_rcp_f32 v169, v169
    v_mul_f32 v170, v168, v131
    v_fma_f32 v170, v213, v132, v170
    v_mul_f32 v171, v213, v131
    v_fma_f32 v171, -v168, v132, v171
    v_mul_f32 v214, v170, v169
    v_mul_f32 v215, v171, v169
    v_lshlrev_b32 v134, 16, v134
    v_lshlrev_b32 v135, 16, v135
    v_lshlrev_b32 v136, 16, v136
    v_mul_f32 v168, 0x3fb8aa3b, v136
    v_exp_f32 v168, v168
    s_nop 0
    v_cvt_pk_bf16_f32 v168, v168, v168
    v_and_b32 v168, 0xffff0000, v168
    v_mul_f32 v169, v168, v134
    v_mul_f32 v170, v168, v135
    v_mul_f32 v169, 0x3fb8aa3b, v169
    v_exp_f32 v169, v169
    v_mul_f32 v170, 0.15915494, v170
    v_rndne_f32 v171, v170
    v_sub_f32 v170, v170, v171
    v_cos_f32 v171, v170
    v_sin_f32 v172, v170
    s_nop 0
    v_mul_f32 v216, v169, v171
    v_mul_f32 v217, v169, v172
    v_add_f32 v168, -1.0, v216
    v_mul_f32 v169, v134, v134
    v_fma_f32 v169, v135, v135, v169
    v_rcp_f32 v169, v169
    v_mul_f32 v170, v168, v134
    v_fma_f32 v170, v217, v135, v170
    v_mul_f32 v171, v217, v134
    v_fma_f32 v171, -v168, v135, v171
    v_mul_f32 v218, v170, v169
    v_mul_f32 v219, v171, v169
    v_mov_b32 v96, v208
    v_mov_b32 v97, v209
    v_mov_b32 v112, v212
    v_mov_b32 v113, v213
    v_mul_f32 v98, v209, v97
    v_mul_f32 v99, v209, v96
    v_fma_f32 v98, v208, v96, -v98
    v_fma_f32 v99, v208, v97, v99
    v_mul_f32 v114, v213, v113
    v_mul_f32 v115, v213, v112
    v_fma_f32 v114, v212, v112, -v114
    v_fma_f32 v115, v212, v113, v115
    v_mul_f32 v100, v209, v99
    v_mul_f32 v101, v209, v98
    v_fma_f32 v100, v208, v98, -v100
    v_fma_f32 v101, v208, v99, v101
    v_mul_f32 v116, v213, v115
    v_mul_f32 v117, v213, v114
    v_fma_f32 v116, v212, v114, -v116
    v_fma_f32 v117, v212, v115, v117
    v_mul_f32 v102, v209, v101
    v_mul_f32 v103, v209, v100
    v_fma_f32 v102, v208, v100, -v102
    v_fma_f32 v103, v208, v101, v103
    v_mul_f32 v118, v213, v117
    v_mul_f32 v119, v213, v116
    v_fma_f32 v118, v212, v116, -v118
    v_fma_f32 v119, v212, v117, v119
    v_mul_f32 v104, v209, v103
    v_mul_f32 v105, v209, v102
    v_fma_f32 v104, v208, v102, -v104
    v_fma_f32 v105, v208, v103, v105
    v_mul_f32 v120, v213, v119
    v_mul_f32 v121, v213, v118
    v_fma_f32 v120, v212, v118, -v120
    v_fma_f32 v121, v212, v119, v121
    v_mul_f32 v106, v209, v105
    v_mul_f32 v107, v209, v104
    v_fma_f32 v106, v208, v104, -v106
    v_fma_f32 v107, v208, v105, v107
    v_mul_f32 v122, v213, v121
    v_mul_f32 v123, v213, v120
    v_fma_f32 v122, v212, v120, -v122
    v_fma_f32 v123, v212, v121, v123
    v_mul_f32 v108, v209, v107
    v_mul_f32 v109, v209, v106
    v_fma_f32 v108, v208, v106, -v108
    v_fma_f32 v109, v208, v107, v109
    v_mul_f32 v124, v213, v123
    v_mul_f32 v125, v213, v122
    v_fma_f32 v124, v212, v122, -v124
    v_fma_f32 v125, v212, v123, v125
    v_mul_f32 v110, v209, v109
    v_mul_f32 v111, v209, v108
    v_fma_f32 v110, v208, v108, -v110
    v_fma_f32 v111, v208, v109, v111
    v_mul_f32 v126, v213, v125
    v_mul_f32 v127, v213, v124
    v_fma_f32 v126, v212, v124, -v126
    v_fma_f32 v127, v212, v125, v127
    v_mov_b32 v220, v216
    v_mov_b32 v221, v217
    v_mul_f32 v168, v221, v221
    v_mul_f32 v169, v220, v221
    v_fma_f32 v168, v220, v220, -v168
    v_fma_f32 v221, v221, v220, v169
    v_mov_b32 v220, v168
    v_mul_f32 v168, v221, v221
    v_mul_f32 v169, v220, v221
    v_fma_f32 v168, v220, v220, -v168
    v_fma_f32 v221, v221, v220, v169
    v_mov_b32 v220, v168
    v_mul_f32 v168, v221, v221
    v_mul_f32 v169, v220, v221
    v_fma_f32 v168, v220, v220, -v168
    v_fma_f32 v221, v221, v220, v169
    v_mov_b32 v220, v168
    v_mul_f32 v168, v221, v221
    v_mul_f32 v169, v220, v221
    v_fma_f32 v168, v220, v220, -v168
    v_fma_f32 v221, v221, v220, v169
    v_mov_b32 v220, v168
    v_mov_b32 v222, v220
    v_mov_b32 v223, v221
    v_mul_f32 v168, v223, v223
    v_mul_f32 v169, v222, v223
    v_fma_f32 v168, v222, v222, -v168
    v_fma_f32 v223, v223, v222, v169
    v_mov_b32 v222, v168
    v_mul_f32 v168, v223, v223
    v_mul_f32 v169, v222, v223
    v_fma_f32 v168, v222, v222, -v168
    v_fma_f32 v223, v223, v222, v169
    v_mov_b32 v222, v168
    v_mul_f32 v168, v223, v223
    v_mul_f32 v169, v222, v223
    v_fma_f32 v168, v222, v222, -v168
    v_fma_f32 v223, v223, v222, v169
    v_mov_b32 v222, v168
    v_mul_f32 v168, v223, v223
    v_mul_f32 v169, v222, v223
    v_fma_f32 v168, v222, v222, -v168
    v_fma_f32 v223, v223, v222, v169
    v_mov_b32 v222, v168
    s_waitcnt vmcnt(9)
    s_barrier
    ds_read_b128 v[144:147], v20 offset:0
    ds_read_b128 v[128:131], v4 offset:0
    ds_read_b128 v[132:135], v4 offset:2048
    ds_read_b128 v[136:139], v4 offset:4096
    ds_read_b128 v[140:143], v4 offset:6144
    ds_read_b128 v[148:151], v20 offset:2048
    ds_read_b128 v[152:155], v20 offset:8192
    ds_read_b128 v[156:159], v20 offset:10240
    s_mov_b32 s56, 0
    s_mov_b32 s57, 49152
    s_mov_b32 s60, 49152
    s_mov_b32 s59, 0
    s_mov_b32 s63, 4294868992
k1s_loop:
    s_cmp_eq_u32 s56, 12
    s_cbranch_scc1 k1s_h
k1s_r:
    s_waitcnt lgkmcnt(0)
    v_mfma_f32_16x16x32_bf16 v[32:35], v[128:131], v[144:147], v[32:35]
    ds_read_b128 v[184:187], v21 offset:0
    v_mfma_f32_16x16x32_bf16 v[36:39], v[132:135], v[144:147], v[36:39]
    ds_read_b128 v[168:171], v5 offset:0
    v_add_u32 v4, s57, v4
    v_add_u32 v20, s57, v20
    s_add_u32 s51, s50, s52
    s_add_u32 m0, s51, 3072
    v_mfma_f32_16x16x32_bf16 v[40:43], v[136:139], v[144:147], v[40:43]
    ds_read_b128 v[172:175], v5 offset:2048
    buffer_load_dwordx4 v15, s[8:11], s54 offen lds
    v_mfma_f32_16x16x32_bf16 v[44:47], v[140:143], v[144:147], v[44:47]
    v_mfma_f32_16x16x32_bf16 v[48:51], v[128:131], v[148:151], v[48:51]
    ds_read_b128 v[176:179], v5 offset:4096
    v_mfma_f32_16x16x32_bf16 v[52:55], v[132:135], v[148:151], v[52:55]
    ds_read_b128 v[180:183], v5 offset:6144
    v_mfma_f32_16x16x32_bf16 v[56:59], v[136:139], v[148:151], v[56:59]
    ds_read_b128 v[188:191], v21 offset:2048
    s_add_u32 s51, s50, s53
    s_add_u32 m0, s51, 0
    v_mfma_f32_16x16x32_bf16 v[60:63], v[140:143], v[148:151], v[60:63]
    buffer_load_dwordx4 v16, s[16:19], s54 offen lds
    v_mfma_f32_16x16x32_bf16 v[64:67], v[128:131], v[152:155], v[64:67]
    ds_read_b128 v[192:195], v21 offset:8192
    v_mfma_f32_16x16x32_bf16 v[68:71], v[132:135], v[152:155], v[68:71]
    ds_read_b128 v[196:199], v21 offset:10240
    v_mfma_f32_16x16x32_bf16 v[72:75], v[136:139], v[152:155], v[72:75]
    v_mfma_f32_16x16x32_bf16 v[76:79], v[140:143], v[152:155], v[76:79]
    s_add_u32 s51, s50, s53
    s_add_u32 m0, s51, 1024
    v_mfma_f32_16x16x32_bf16 v[80:83], v[128:131], v[156:159], v[80:83]
    buffer_load_dwordx4 v17, s[16:19], s54 offen lds
    v_mfma_f32_16x16x32_bf16 v[84:87], v[132:135], v[156:159], v[84:87]
    s_add_u32 s54, s54, 128
    s_mul_i32 s50, s59, s60
    s_cmp_ge_u32 s56, 13
    s_cselect_b32 s10, 0, s10
    s_cselect_b32 s18, 0, s18
    v_mfma_f32_16x16x32_bf16 v[88:91], v[136:139], v[156:159], v[88:91]
    v_mfma_f32_16x16x32_bf16 v[92:95], v[140:143], v[156:159], v[92:95]
    s_waitcnt vmcnt(6) lgkmcnt(0)
    s_barrier
    v_mfma_f32_16x16x32_bf16 v[32:35], v[168:171], v[184:187], v[32:35]
    ds_read_b128 v[144:147], v20 offset:0
    v_mfma_f32_16x16x32_bf16 v[36:39], v[172:175], v[184:187], v[36:39]
    ds_read_b128 v[128:131], v4 offset:0
    s_add_u32 s51, s50, s52
    s_add_u32 m0, s51, 0
    v_mfma_f32_16x16x32_bf16 v[40:43], v[176:179], v[184:187], v[40:43]
    ds_read_b128 v[132:135], v4 offset:2048
    buffer_load_dwordx4 v12, s[8:11], s54 offen lds
    v_mfma_f32_16x16x32_bf16 v[44:47], v[180:183], v[184:187], v[44:47]
    ds_read_b128 v[136:139], v4 offset:4096
    v_mfma_f32_16x16x32_bf16 v[48:51], v[168:171], v[188:191], v[48:51]
    v_mfma_f32_16x16x32_bf16 v[52:55], v[172:175], v[188:191], v[52:55]
    ds_read_b128 v[140:143], v4 offset:6144
    v_mfma_f32_16x16x32_bf16 v[56:59], v[176:179], v[188:191], v[56:59]
    ds_read_b128 v[148:151], v20 offset:2048
    s_add_u32 s51, s50, s52
    s_add_u32 m0, s51, 1024
    v_mfma_f32_16x16x32_bf16 v[60:63], v[180:183], v[188:191], v[60:63]
    ds_read_b128 v[152:155], v20 offset:8192
    buffer_load_dwordx4 v13, s[8:11], s54 offen lds
    v_mfma_f32_16x16x32_bf16 v[64:67], v[168:171], v[192:195], v[64:67]
    ds_read_b128 v[156:159], v20 offset:10240
    v_mfma_f32_16x16x32_bf16 v[68:71], v[172:175], v[192:195], v[68:71]
    v_mfma_f32_16x16x32_bf16 v[72:75], v[176:179], v[192:195], v[72:75]
    v_mfma_f32_16x16x32_bf16 v[76:79], v[180:183], v[192:195], v[76:79]
    s_add_u32 s51, s50, s52
    s_add_u32 m0, s51, 2048
    v_mfma_f32_16x16x32_bf16 v[80:83], v[168:171], v[196:199], v[80:83]
    buffer_load_dwordx4 v14, s[8:11], s54 offen lds
    v_mfma_f32_16x16x32_bf16 v[84:87], v[172:175], v[196:199], v[84:87]
    v_mfma_f32_16x16x32_bf16 v[88:91], v[176:179], v[196:199], v[88:91]
    v_add_u32 v5, s57, v5
    v_add_u32 v21, s57, v21
    s_add_u32 s59, s59, 1
    s_cmp_eq_u32 s59, 3
    s_cselect_b32 s59, 0, s59
    v_mfma_f32_16x16x32_bf16 v[92:95], v[180:183], v[196:199], v[92:95]
    s_cmp_eq_u32 s59, 2
    s_cselect_b32 s57, s63, s60
    s_add_u32 s56, s56, 1
    s_cmp_lt_u32 s56, 16
    s_cbranch_scc1 k1s_loop
    s_waitcnt vmcnt(0) lgkmcnt(0)
    s_barrier
    s_nop 7
    s_mov_b32 s10, 0x400000
    s_lshl_b32 s84, s4, 4
    s_add_u32 s84, s84, s5
    s_lshl_b32 s84, s84, 4
    s_mul_i32 s68, s3, 3
    s_sub_u32 s68, s68, 3
    s_max_i32 s68, s68, 0
    s_add_u32 s84, s84, s68
    s_lshl_b32 s48, s84, 11
    s_add_u32 s49, s48, 4096
    v_lshlrev_b32 v26, 4, v1
    buffer_load_dwordx4 v[224:227], v26, s[8:11], s48 offen offset:0
    buffer_load_dwordx4 v[228:231], v26, s[8:11], s48 offen offset:1024
    buffer_load_dwordx4 v[232:235], v26, s[8:11], s48 offen offset:2048
    buffer_load_dwordx4 v[236:239], v26, s[8:11], s48 offen offset:3072
    buffer_load_dwordx4 v[240:243], v26, s[8:11], s49 offen offset:0
    buffer_load_dwordx4 v[244:247], v26, s[8:11], s49 offen offset:1024
    buffer_load_dwordx4 v[152:155], v26, s[76:79], 0 offen offset:0
    buffer_load_dwordx4 v[156:159], v26, s[76:79], 0 offen offset:1024
k1s_ng:
    v_readfirstlane_b32 s85, v30
    s_cmp_lg_u32 s85, 0
    s_cbranch_scc1 k1s_ng2
    buffer_load_dword v30, v31, s[80:83], 0 offen sc1
    s_waitcnt vmcnt(0)
    s_branch k1s_ng
k1s_ng2:
    v_fma_f32 v33, -v209, v64, v33
    v_fma_f32 v65, v209, v32, v65
    v_fma_f32 v49, -v213, v80, v49
    v_fma_f32 v81, v213, v48, v81
    v_fma_f32 v33, v208, v32, v33
    v_fma_f32 v65, v208, v64, v65
    v_fma_f32 v49, v212, v48, v49
    v_fma_f32 v81, v212, v80, v81
    v_fma_f32 v34, -v209, v65, v34
    v_fma_f32 v66, v209, v33, v66
    v_fma_f32 v50, -v213, v81, v50
    v_fma_f32 v82, v213, v49, v82
    v_fma_f32 v34, v208, v33, v34
    v_fma_f32 v66, v208, v65, v66
    v_fma_f32 v50, v212, v49, v50
    v_fma_f32 v82, v212, v81, v82
    v_fma_f32 v35, -v209, v66, v35
    v_fma_f32 v67, v209, v34, v67
    v_fma_f32 v51, -v213, v82, v51
    v_fma_f32 v83, v213, v50, v83
    v_fma_f32 v35, v208, v34, v35
    v_fma_f32 v67, v208, v66, v67
    v_fma_f32 v51, v212, v50, v51
    v_fma_f32 v83, v212, v82, v83
    v_fma_f32 v36, -v209, v67, v36
    v_fma_f32 v68, v209, v35, v68
    v_fma_f32 v52, -v213, v83, v52
    v_fma_f32 v84, v213, v51, v84
    v_fma_f32 v36, v208, v35, v36
    v_fma_f32 v68, v208, v67, v68
    v_fma_f32 v52, v212, v51, v52
    v_fma_f32 v84, v212, v83, v84
    v_fma_f32 v37, -v209, v68, v37
    v_fma_f32 v69, v209, v36, v69
    v_fma_f32 v53, -v213, v84, v53
    v_fma_f32 v85, v213, v52, v85
    v_fma_f32 v37, v208, v36, v37
    v_fma_f32 v69, v208, v68, v69
    v_fma_f32 v53, v212, v52, v53
    v_fma_f32 v85, v212, v84, v85
    v_fma_f32 v38, -v209, v69, v38
    v_fma_f32 v70, v209, v37, v70
    v_fma_f32 v54, -v213, v85, v54
    v_fma_f32 v86, v213, v53, v86
    v_fma_f32 v38, v208, v37, v38
    v_fma_f32 v70, v208, v69, v70
    v_fma_f32 v54, v212, v53, v54
    v_fma_f32 v86, v212, v85, v86
    v_fma_f32 v39, -v209, v70, v39
    v_fma_f32 v71, v209, v38, v71
    v_fma_f32 v55, -v213, v86, v55
    v_fma_f32 v87, v213, v54, v87
    v_fma_f32 v39, v208, v38, v39
    v_fma_f32 v71, v208, v70, v71
    v_fma_f32 v55, v212, v54, v55
    v_fma_f32 v87, v212, v86, v87
    v_fma_f32 v40, -v209, v71, v40
    v_fma_f32 v72, v209, v39, v72
    v_fma_f32 v56, -v213, v87, v56
    v_fma_f32 v88, v213, v55, v88
    v_fma_f32 v40, v208, v39, v40
    v_fma_f32 v72, v208, v71, v72
    v_fma_f32 v56, v212, v55, v56
    v_fma_f32 v88, v212, v87, v88
    v_fma_f32 v41, -v209, v72, v41
    v_fma_f32 v73, v209, v40, v73
    v_fma_f32 v57, -v213, v88, v57
    v_fma_f32 v89, v213, v56, v89
    v_fma_f32 v41, v208, v40, v41
    v_fma_f32 v73, v208, v72, v73
    v_fma_f32 v57, v212, v56, v57
    v_fma_f32 v89, v212, v88, v89
    v_fma_f32 v42, -v209, v73, v42
    v_fma_f32 v74, v209, v41, v74
    v_fma_f32 v58, -v213, v89, v58
    v_fma_f32 v90, v213, v57, v90
    v_fma_f32 v42, v208, v41, v42
    v_fma_f32 v74, v208, v73, v74
    v_fma_f32 v58, v212, v57, v58
    v_fma_f32 v90, v212, v89, v90
    v_fma_f32 v43, -v209, v74, v43
    v_fma_f32 v75, v209, v42, v75
    v_fma_f32 v59, -v213, v90, v59
    v_fma_f32 v91, v213, v58, v91
    v_fma_f32 v43, v208, v42, v43
    v_fma_f32 v75, v208, v74, v75
    v_fma_f32 v59, v212, v58, v59
    v_fma_f32 v91, v212, v90, v91
    v_fma_f32 v44, -v209, v75, v44
    v_fma_f32 v76, v209, v43, v76
    v_fma_f32 v60, -v213, v91, v60
    v_fma_f32 v92, v213, v59, v92
    v_fma_f32 v44, v208, v43, v44
    v_fma_f32 v76, v208, v75, v76
    v_fma_f32 v60, v212, v59, v60
    v_fma_f32 v92, v212, v91, v92
    v_fma_f32 v45, -v209, v76, v45
    v_fma_f32 v77, v209, v44, v77
    v_fma_f32 v61, -v213, v92, v61
    v_fma_f32 v93, v213, v60, v93
    v_fma_f32 v45, v208, v44, v45
    v_fma_f32 v77, v208, v76, v77
    v_fma_f32 v61, v212, v60, v61
    v_fma_f32 v93, v212, v92, v93
    v_fma_f32 v46, -v209, v77, v46
    v_fma_f32 v78, v209, v45, v78
    v_fma_f32 v62, -v213, v93, v62
    v_fma_f32 v94, v213, v61, v94
    v_fma_f32 v46, v208, v45, v46
    v_fma_f32 v78, v208, v77, v78
    v_fma_f32 v62, v212, v61, v62
    v_fma_f32 v94, v212, v93, v94
    v_fma_f32 v47, -v209, v78, v47
    v_fma_f32 v79, v209, v46, v79
    v_fma_f32 v63, -v213, v94, v63
    v_fma_f32 v95, v213, v62, v95
    v_fma_f32 v47, v208, v46, v47
    v_fma_f32 v79, v208, v78, v79
    v_fma_f32 v63, v212, v62, v63
    v_fma_f32 v95, v212, v94, v95
    v_mov_b32 v128, v47
    v_mov_b32 v129, v79
    v_mov_b32 v130, v63
    v_mov_b32 v131, v95
    s_lshl_b32 s48, s6, 8
    s_lshl_b32 s49, s7, 5
    s_add_u32 s48, s48, s49
    v_lshl_add_u32 v24, v3, 6, v2
    v_add_u32 v24, s48, v24
    v_lshlrev_b32 v24, 3, v24
    ds_write_b64 v24, v[128:129] offset:0
    ds_write_b64 v24, v[130:131] offset:128
    s_lshl_b32 s48, s4, 1
    s_lshr_b32 s49, s6, 1
    s_add_u32 s48, s48, s49
    s_mul_i32 s64, s48, 1441792
    s_and_b32 s49, s6, 1
    s_lshl_b32 s49, s49, 12
    s_add_u32 s64, s64, s49
    s_lshl_b32 s69, s4, 12
    s_lshl_b32 s49, s5, 7
    s_add_u32 s69, s69, s49
    s_add_u32 s70, s69, 25493504
    s_waitcnt lgkmcnt(0)
    s_barrier
    s_cmp_eq_u32 s3, 0
    s_cbranch_scc1 k1s_w0
    s_waitcnt vmcnt(0)
    s_mov_b32 s72, s94
    s_and_b32 s73, s95, 0xffff
    s_mov_b32 s74, 0x700000
    s_mov_b32 s75, 0x20000
    s_lshl_b32 s48, s4, 4
    s_add_u32 s48, s48, s5
    s_mul_i32 s48, s48, 7
    s_add_u32 s48, s48, s3
    s_sub_u32 s48, s48, 1
    s_lshl_b32 s48, s48, 13
    v_lshlrev_b32 v250, 7, v1
    v_add_u32 v250, s48, v250
    buffer_load_dword v251, v250, s[72:75], 0 offen
    buffer_load_dword v251, v250, s[72:75], 0 offen offset:64
    v_lshlrev_b32 v176, 16, v152
    v_and_b32 v177, 0xffff0000, v152
    v_lshlrev_b32 v178, 16, v153
    v_and_b32 v179, 0xffff0000, v153
    v_lshlrev_b32 v180, 16, v154
    v_and_b32 v181, 0xffff0000, v154
    v_lshlrev_b32 v182, 16, v155
    v_and_b32 v183, 0xffff0000, v155
    v_lshlrev_b32 v184, 16, v156
    v_and_b32 v185, 0xffff0000, v156
    v_lshlrev_b32 v186, 16, v157
    v_and_b32 v187, 0xffff0000, v157
    v_lshlrev_b32 v188, 16, v158
    v_and_b32 v189, 0xffff0000, v158
    v_lshlrev_b32 v190, 16, v159
    v_and_b32 v191, 0xffff0000, v159
    v_mov_b32 v144, 0
    v_lshlrev_b32 v140, 16, v224
    v_and_b32 v141, 0xffff0000, v224
    v_mul_f32 v140, v140, v176
    v_mul_f32 v141, v141, v177
    v_cvt_pk_bf16_f32 v140, v140, v141
    v_lshlrev_b32 v141, 16, v140
    v_and_b32 v140, 0xffff0000, v140
    v_add_f32 v144, v144, v141
    v_add_f32 v144, v144, v140
    v_lshlrev_b32 v140, 16, v225
    v_and_b32 v141, 0xffff0000, v225
    v_mul_f32 v140, v140, v178
    v_mul_f32 v141, v141, v179
    v_cvt_pk_bf16_f32 v140, v140, v141
    v_lshlrev_b32 v141, 16, v140
    v_and_b32 v140, 0xffff0000, v140
    v_add_f32 v144, v144, v141
    v_add_f32 v144, v144, v140
    v_lshlrev_b32 v140, 16, v226
    v_and_b32 v141, 0xffff0000, v226
    v_mul_f32 v140, v140, v180
    v_mul_f32 v141, v141, v181
    v_cvt_pk_bf16_f32 v140, v140, v141
    v_lshlrev_b32 v141, 16, v140
    v_and_b32 v140, 0xffff0000, v140
    v_add_f32 v144, v144, v141
    v_add_f32 v144, v144, v140
    v_lshlrev_b32 v140, 16, v227
    v_and_b32 v141, 0xffff0000, v227
    v_mul_f32 v140, v140, v182
    v_mul_f32 v141, v141, v183
    v_cvt_pk_bf16_f32 v140, v140, v141
    v_lshlrev_b32 v141, 16, v140
    v_and_b32 v140, 0xffff0000, v140
    v_add_f32 v144, v144, v141
    v_add_f32 v144, v144, v140
    v_lshlrev_b32 v140, 16, v228
    v_and_b32 v141, 0xffff0000, v228
    v_mul_f32 v140, v140, v184
    v_mul_f32 v141, v141, v185
    v_cvt_pk_bf16_f32 v140, v140, v141
    v_lshlrev_b32 v141, 16, v140
    v_and_b32 v140, 0xffff0000, v140
    v_add_f32 v144, v144, v141
    v_add_f32 v144, v144, v140
    v_lshlrev_b32 v140, 16, v229
    v_and_b32 v141, 0xffff0000, v229
    v_mul_f32 v140, v140, v186
    v_mul_f32 v141, v141, v187
    v_cvt_pk_bf16_f32 v140, v140, v141
    v_lshlrev_b32 v141, 16, v140
    v_and_b32 v140, 0xffff0000, v140
    v_add_f32 v144, v144, v141
    v_add_f32 v144, v144, v140
    v_lshlrev_b32 v140, 16, v230
    v_and_b32 v141, 0xffff0000, v230
    v_mul_f32 v140, v140, v188
    v_mul_f32 v141, v141, v189
    v_cvt_pk_bf16_f32 v140, v140, v141
    v_lshlrev_b32 v141, 16, v140
    v_and_b32 v140, 0xffff0000, v140
    v_add_f32 v144, v144, v141
    v_add_f32 v144, v144, v140
    v_lshlrev_b32 v140, 16, v231
    v_and_b32 v141, 0xffff0000, v231
    v_mul_f32 v140, v140, v190
    v_mul_f32 v141, v141, v191
    v_cvt_pk_bf16_f32 v140, v140, v141
    v_lshlrev_b32 v141, 16, v140
    v_and_b32 v140, 0xffff0000, v140
    v_add_f32 v144, v144, v141
    v_add_f32 v144, v144, v140
    v_mov_b32 v145, 0
    v_lshlrev_b32 v140, 16, v232
    v_and_b32 v141, 0xffff0000, v232
    v_mul_f32 v140, v140, v176
    v_mul_f32 v141, v141, v177
    v_cvt_pk_bf16_f32 v140, v140, v141
    v_lshlrev_b32 v141, 16, v140
    v_and_b32 v140, 0xffff0000, v140
    v_add_f32 v145, v145, v141
    v_add_f32 v145, v145, v140
    v_lshlrev_b32 v140, 16, v233
    v_and_b32 v141, 0xffff0000, v233
    v_mul_f32 v140, v140, v178
    v_mul_f32 v141, v141, v179
    v_cvt_pk_bf16_f32 v140, v140, v141
    v_lshlrev_b32 v141, 16, v140
    v_and_b32 v140, 0xffff0000, v140
    v_add_f32 v145, v145, v141
    v_add_f32 v145, v145, v140
    v_lshlrev_b32 v140, 16, v234
    v_and_b32 v141, 0xffff0000, v234
    v_mul_f32 v140, v140, v180
    v_mul_f32 v141, v141, v181
    v_cvt_pk_bf16_f32 v140, v140, v141
    v_lshlrev_b32 v141, 16, v140
    v_and_b32 v140, 0xffff0000, v140
    v_add_f32 v145, v145, v141
    v_add_f32 v145, v145, v140
    v_lshlrev_b32 v140, 16, v235
    v_and_b32 v141, 0xffff0000, v235
    v_mul_f32 v140, v140, v182
    v_mul_f32 v141, v141, v183
    v_cvt_pk_bf16_f32 v140, v140, v141
    v_lshlrev_b32 v141, 16, v140
    v_and_b32 v140, 0xffff0000, v140
    v_add_f32 v145, v145, v141
    v_add_f32 v145, v145, v140
    v_lshlrev_b32 v140, 16, v236
    v_and_b32 v141, 0xffff0000, v236
    v_mul_f32 v140, v140, v184
    v_mul_f32 v141, v141, v185
    v_cvt_pk_bf16_f32 v140, v140, v141
    v_lshlrev_b32 v141, 16, v140
    v_and_b32 v140, 0xffff0000, v140
    v_add_f32 v145, v145, v141
    v_add_f32 v145, v145, v140
    v_lshlrev_b32 v140, 16, v237
    v_and_b32 v141, 0xffff0000, v237
    v_mul_f32 v140, v140, v186
    v_mul_f32 v141, v141, v187
    v_cvt_pk_bf16_f32 v140, v140, v141
    v_lshlrev_b32 v141, 16, v140
    v_and_b32 v140, 0xffff0000, v140
    v_add_f32 v145, v145, v141
    v_add_f32 v145, v145, v140
    v_lshlrev_b32 v140, 16, v238
    v_and_b32 v141, 0xffff0000, v238
    v_mul_f32 v140, v140, v188
    v_mul_f32 v141, v141, v189
    v_cvt_pk_bf16_f32 v140, v140, v141
    v_lshlrev_b32 v141, 16, v140
    v_and_b32 v140, 0xffff0000, v140
    v_add_f32 v145, v145, v141
    v_add_f32 v145, v145, v140
    v_lshlrev_b32 v140, 16, v239
    v_and_b32 v141, 0xffff0000, v239
    v_mul_f32 v140, v140, v190
    v_mul_f32 v141, v141, v191
    v_cvt_pk_bf16_f32 v140, v140, v141
    v_lshlrev_b32 v141, 16, v140
    v_and_b32 v140, 0xffff0000, v140
    v_add_f32 v145, v145, v141
    v_add_f32 v145, v145, v140
    v_mov_b32 v146, 0
    v_lshlrev_b32 v140, 16, v240
    v_and_b32 v141, 0xffff0000, v240
    v_mul_f32 v140, v140, v176
    v_mul_f32 v141, v141, v177
    v_cvt_pk_bf16_f32 v140, v140, v141
    v_lshlrev_b32 v141, 16, v140
    v_and_b32 v140, 0xffff0000, v140
    v_add_f32 v146, v146, v141
    v_add_f32 v146, v146, v140
    v_lshlrev_b32 v140, 16, v241
    v_and_b32 v141, 0xffff0000, v241
    v_mul_f32 v140, v140, v178
    v_mul_f32 v141, v141, v179
    v_cvt_pk_bf16_f32 v140, v140, v141
    v_lshlrev_b32 v141, 16, v140
    v_and_b32 v140, 0xffff0000, v140
    v_add_f32 v146, v146, v141
    v_add_f32 v146, v146, v140
    v_lshlrev_b32 v140, 16, v242
    v_and_b32 v141, 0xffff0000, v242
    v_mul_f32 v140, v140, v180
    v_mul_f32 v141, v141, v181
    v_cvt_pk_bf16_f32 v140, v140, v141
    v_lshlrev_b32 v141, 16, v140
    v_and_b32 v140, 0xffff0000, v140
    v_add_f32 v146, v146, v141
    v_add_f32 v146, v146, v140
    v_lshlrev_b32 v140, 16, v243
    v_and_b32 v141, 0xffff0000, v243
    v_mul_f32 v140, v140, v182
    v_mul_f32 v141, v141, v183
    v_cvt_pk_bf16_f32 v140, v140, v141
    v_lshlrev_b32 v141, 16, v140
    v_and_b32 v140, 0xffff0000, v140
    v_add_f32 v146, v146, v141
    v_add_f32 v146, v146, v140
    v_lshlrev_b32 v140, 16, v244
    v_and_b32 v141, 0xffff0000, v244
    v_mul_f32 v140, v140, v184
    v_mul_f32 v141, v141, v185
    v_cvt_pk_bf16_f32 v140, v140, v141
    v_lshlrev_b32 v141, 16, v140
    v_and_b32 v140, 0xffff0000, v140
    v_add_f32 v146, v146, v141
    v_add_f32 v146, v146, v140
    v_lshlrev_b32 v140, 16, v245
    v_and_b32 v141, 0xffff0000, v245
    v_mul_f32 v140, v140, v186
    v_mul_f32 v141, v141, v187
    v_cvt_pk_bf16_f32 v140, v140, v141
    v_lshlrev_b32 v141, 16, v140
    v_and_b32 v140, 0xffff0000, v140
    v_add_f32 v146, v146, v141
    v_add_f32 v146, v146, v140
    v_lshlrev_b32 v140, 16, v246
    v_and_b32 v141, 0xffff0000, v246
    v_mul_f32 v140, v140, v188
    v_mul_f32 v141, v141, v189
    v_cvt_pk_bf16_f32 v140, v140, v141
    v_lshlrev_b32 v141, 16, v140
    v_and_b32 v140, 0xffff0000, v140
    v_add_f32 v146, v146, v141
    v_add_f32 v146, v146, v140
    v_lshlrev_b32 v140, 16, v247
    v_and_b32 v141, 0xffff0000, v247
    v_mul_f32 v140, v140, v190
    v_mul_f32 v141, v141, v191
    v_cvt_pk_bf16_f32 v140, v140, v141
    v_lshlrev_b32 v141, 16, v140
    v_and_b32 v140, 0xffff0000, v140
    v_add_f32 v146, v146, v141
    v_add_f32 v146, v146, v140
    ds_swizzle_b32 v140, v144 offset:0x41f
    ds_swizzle_b32 v141, v145 offset:0x41f
    ds_swizzle_b32 v142, v146 offset:0x41f
    s_waitcnt lgkmcnt(0)
    v_add_f32 v144, v144, v140
    v_add_f32 v145, v145, v141
    v_add_f32 v146, v146, v142
    ds_swizzle_b32 v140, v144 offset:0x81f
    ds_swizzle_b32 v141, v145 offset:0x81f
    ds_swizzle_b32 v142, v146 offset:0x81f
    s_waitcnt lgkmcnt(0)
    v_add_f32 v144, v144, v140
    v_add_f32 v145, v145, v141
    v_add_f32 v146, v146, v142
    ds_swizzle_b32 v140, v144 offset:0x101f
    ds_swizzle_b32 v141, v145 offset:0x101f
    ds_swizzle_b32 v142, v146 offset:0x101f
    s_waitcnt lgkmcnt(0)
    v_add_f32 v144, v144, v140
    v_add_f32 v145, v145, v141
    v_add_f32 v146, v146, v142
    ds_swizzle_b32 v140, v144 offset:0x201f
    ds_swizzle_b32 v141, v145 offset:0x201f
    ds_swizzle_b32 v142, v146 offset:0x201f
    s_waitcnt lgkmcnt(0)
    v_add_f32 v144, v144, v140
    v_add_f32 v145, v145, v141
    v_add_f32 v146, v146, v142
    ds_swizzle_b32 v140, v144 offset:0x401f
    ds_swizzle_b32 v141, v145 offset:0x401f
    ds_swizzle_b32 v142, v146 offset:0x401f
    s_waitcnt lgkmcnt(0)
    v_add_f32 v144, v144, v140
    v_add_f32 v145, v145, v141
    v_add_f32 v146, v146, v142
    s_nop 0
    v_readlane_b32 s48, v144, 32
    v_readlane_b32 s49, v145, 32
    v_readlane_b32 s50, v146, 32
    s_nop 1
    v_add_f32 v144, s48, v144
    v_add_f32 v145, s49, v145
    v_add_f32 v146, s50, v146
    v_cmp_eq_u32 vcc, 0, v1
    v_cmp_eq_u32 s[48:49], 2, v1
    s_nop 1
    v_cndmask_b32 v140, v145, v144, vcc
    v_cndmask_b32 v140, v140, v146, s[48:49]
    v_cvt_pk_bf16_f32 v140, v140, v140
    v_and_b32 v140, 0xffff0000, v140
    v_mul_f32 v140, 0xbfb8aa3b, v140
    v_exp_f32 v140, v140
    s_nop 0
    v_add_f32 v140, 1.0, v140
    v_rcp_f32 v140, v140
    s_nop 0
    v_cvt_pk_bf16_f32 v140, v140, v140
    v_and_b32 v140, 0xffff0000, v140
    s_lshl_b32 s48, s84, 2
    s_add_u32 s48, s48, 25165824
    v_lshlrev_b32 v141, 2, v1
    v_add_u32 v142, s68, v1
    v_cmp_gt_u32 vcc, 16, v142
    s_and_b32 vcc_lo, vcc_lo, 7
    s_mov_b32 vcc_hi, 0
    s_mov_b64 exec, vcc
    s_cbranch_execz k1s_nog
    buffer_store_dword v140, v141, s[24:27], s48 offen sc1
k1s_nog:
    s_mov_b64 exec, -1
    v_mul_f32 v132, v211, v64
    v_mul_f32 v133, v211, v32
    v_fma_f32 v32, v210, v32, -v132
    v_fma_f32 v64, -v210, v64, -v133
    v_mul_f32 v134, v215, v80
    v_mul_f32 v135, v215, v48
    v_fma_f32 v48, v214, v48, -v134
    v_fma_f32 v80, -v214, v80, -v135
    v_mul_f32 v132, v211, v65
    v_mul_f32 v133, v211, v33
    v_fma_f32 v33, v210, v33, -v132
    v_fma_f32 v65, -v210, v65, -v133
    v_mul_f32 v134, v215, v81
    v_mul_f32 v135, v215, v49
    v_fma_f32 v49, v214, v49, -v134
    v_fma_f32 v81, -v214, v81, -v135
    v_mul_f32 v132, v211, v66
    v_mul_f32 v133, v211, v34
    v_fma_f32 v34, v210, v34, -v132
    v_fma_f32 v66, -v210, v66, -v133
    v_mul_f32 v134, v215, v82
    v_mul_f32 v135, v215, v50
    v_fma_f32 v50, v214, v50, -v134
    v_fma_f32 v82, -v214, v82, -v135
    v_mul_f32 v132, v211, v67
    v_mul_f32 v133, v211, v35
    v_fma_f32 v35, v210, v35, -v132
    v_fma_f32 v67, -v210, v67, -v133
    v_mul_f32 v134, v215, v83
    v_mul_f32 v135, v215, v51
    v_fma_f32 v51, v214, v51, -v134
    v_fma_f32 v83, -v214, v83, -v135
    v_mul_f32 v132, v211, v68
    v_mul_f32 v133, v211, v36
    v_fma_f32 v36, v210, v36, -v132
    v_fma_f32 v68, -v210, v68, -v133
    v_mul_f32 v134, v215, v84
    v_mul_f32 v135, v215, v52
    v_fma_f32 v52, v214, v52, -v134
    v_fma_f32 v84, -v214, v84, -v135
    v_mul_f32 v132, v211, v69
    v_mul_f32 v133, v211, v37
    v_fma_f32 v37, v210, v37, -v132
    v_fma_f32 v69, -v210, v69, -v133
    v_mul_f32 v134, v215, v85
    v_mul_f32 v135, v215, v53
    v_fma_f32 v53, v214, v53, -v134
    v_fma_f32 v85, -v214, v85, -v135
    v_mul_f32 v132, v211, v70
    v_mul_f32 v133, v211, v38
    v_fma_f32 v38, v210, v38, -v132
    v_fma_f32 v70, -v210, v70, -v133
    v_mul_f32 v134, v215, v86
    v_mul_f32 v135, v215, v54
    v_fma_f32 v54, v214, v54, -v134
    v_fma_f32 v86, -v214, v86, -v135
    v_mul_f32 v132, v211, v71
    v_mul_f32 v133, v211, v39
    v_fma_f32 v39, v210, v39, -v132
    v_fma_f32 v71, -v210, v71, -v133
    v_mul_f32 v134, v215, v87
    v_mul_f32 v135, v215, v55
    v_fma_f32 v55, v214, v55, -v134
    v_fma_f32 v87, -v214, v87, -v135
    v_mul_f32 v132, v211, v72
    v_mul_f32 v133, v211, v40
    v_fma_f32 v40, v210, v40, -v132
    v_fma_f32 v72, -v210, v72, -v133
    v_mul_f32 v134, v215, v88
    v_mul_f32 v135, v215, v56
    v_fma_f32 v56, v214, v56, -v134
    v_fma_f32 v88, -v214, v88, -v135
    v_mul_f32 v132, v211, v73
    v_mul_f32 v133, v211, v41
    v_fma_f32 v41, v210, v41, -v132
    v_fma_f32 v73, -v210, v73, -v133
    v_mul_f32 v134, v215, v89
    v_mul_f32 v135, v215, v57
    v_fma_f32 v57, v214, v57, -v134
    v_fma_f32 v89, -v214, v89, -v135
    v_mul_f32 v132, v211, v74
    v_mul_f32 v133, v211, v42
    v_fma_f32 v42, v210, v42, -v132
    v_fma_f32 v74, -v210, v74, -v133
    v_mul_f32 v134, v215, v90
    v_mul_f32 v135, v215, v58
    v_fma_f32 v58, v214, v58, -v134
    v_fma_f32 v90, -v214, v90, -v135
    v_mul_f32 v132, v211, v75
    v_mul_f32 v133, v211, v43
    v_fma_f32 v43, v210, v43, -v132
    v_fma_f32 v75, -v210, v75, -v133
    v_mul_f32 v134, v215, v91
    v_mul_f32 v135, v215, v59
    v_fma_f32 v59, v214, v59, -v134
    v_fma_f32 v91, -v214, v91, -v135
    v_mul_f32 v132, v211, v76
    v_mul_f32 v133, v211, v44
    v_fma_f32 v44, v210, v44, -v132
    v_fma_f32 v76, -v210, v76, -v133
    v_mul_f32 v134, v215, v92
    v_mul_f32 v135, v215, v60
    v_fma_f32 v60, v214, v60, -v134
    v_fma_f32 v92, -v214, v92, -v135
    v_mul_f32 v132, v211, v77
    v_mul_f32 v133, v211, v45
    v_fma_f32 v45, v210, v45, -v132
    v_fma_f32 v77, -v210, v77, -v133
    v_mul_f32 v134, v215, v93
    v_mul_f32 v135, v215, v61
    v_fma_f32 v61, v214, v61, -v134
    v_fma_f32 v93, -v214, v93, -v135
    v_mul_f32 v132, v211, v78
    v_mul_f32 v133, v211, v46
    v_fma_f32 v46, v210, v46, -v132
    v_fma_f32 v78, -v210, v78, -v133
    v_mul_f32 v134, v215, v94
    v_mul_f32 v135, v215, v62
    v_fma_f32 v62, v214, v62, -v134
    v_fma_f32 v94, -v214, v94, -v135
    v_mul_f32 v132, v211, v79
    v_mul_f32 v133, v211, v47
    v_fma_f32 v47, v210, v47, -v132
    v_fma_f32 v79, -v210, v79, -v133
    v_mul_f32 v134, v215, v95
    v_mul_f32 v135, v215, v63
    v_fma_f32 v63, v214, v63, -v134
    v_fma_f32 v95, -v214, v95, -v135
    s_branch k1s_join
k1s_w0:
    v_lshlrev_b32 v28, 3, v1
    ds_read_b64 v[176:177], v28 offset:0
    ds_read_b64 v[178:179], v28 offset:512
    ds_read_b64 v[180:181], v28 offset:1024
    ds_read_b64 v[182:183], v28 offset:1536
    ds_read_b64 v[184:185], v28 offset:2048
    ds_read_b64 v[186:187], v28 offset:2560
    ds_read_b64 v[188:189], v28 offset:3072
    ds_read_b64 v[190:191], v28 offset:3584
    ds_read_b64 v[192:193], v28 offset:4096
    ds_read_b64 v[194:195], v28 offset:4608
    ds_read_b64 v[196:197], v28 offset:5120
    ds_read_b64 v[198:199], v28 offset:5632
    ds_read_b64 v[200:201], v28 offset:6144
    ds_read_b64 v[202:203], v28 offset:6656
    ds_read_b64 v[204:205], v28 offset:7168
    ds_read_b64 v[206:207], v28 offset:7680
    s_lshl_b32 s66, s5, 13
    s_add_u32 s66, s66, 25231360
    s_lshl_b32 s48, s4, 10
    s_add_u32 s48, s48, s66
    s_add_u32 s67, s66, 4096
    s_waitcnt lgkmcnt(0)
    v_mov_b32 v144, v176
    v_mov_b32 v145, v177
    v_fma_f32 v136, -v221, v145, v178
    v_fma_f32 v137, v221, v144, v179
    v_fma_f32 v144, v220, v144, v136
    v_fma_f32 v145, v220, v145, v137
    v_fma_f32 v136, -v221, v145, v180
    v_fma_f32 v137, v221, v144, v181
    v_fma_f32 v144, v220, v144, v136
    v_fma_f32 v145, v220, v145, v137
    v_fma_f32 v136, -v221, v145, v182
    v_fma_f32 v137, v221, v144, v183
    v_fma_f32 v144, v220, v144, v136
    v_fma_f32 v145, v220, v145, v137
    v_fma_f32 v136, -v221, v145, v184
    v_fma_f32 v137, v221, v144, v185
    v_fma_f32 v144, v220, v144, v136
    v_fma_f32 v145, v220, v145, v137
    v_fma_f32 v136, -v221, v145, v186
    v_fma_f32 v137, v221, v144, v187
    v_fma_f32 v144, v220, v144, v136
    v_fma_f32 v145, v220, v145, v137
    v_fma_f32 v136, -v221, v145, v188
    v_fma_f32 v137, v221, v144, v189
    v_fma_f32 v144, v220, v144, v136
    v_fma_f32 v145, v220, v145, v137
    v_fma_f32 v136, -v221, v145, v190
    v_fma_f32 v137, v221, v144, v191
    v_fma_f32 v144, v220, v144, v136
    v_fma_f32 v145, v220, v145, v137
    v_fma_f32 v136, -v221, v145, v192
    v_fma_f32 v137, v221, v144, v193
    v_fma_f32 v144, v220, v144, v136
    v_fma_f32 v145, v220, v145, v137
    v_fma_f32 v136, -v221, v145, v194
    v_fma_f32 v137, v221, v144, v195
    v_fma_f32 v144, v220, v144, v136
    v_fma_f32 v145, v220, v145, v137
    v_fma_f32 v136, -v221, v145, v196
    v_fma_f32 v137, v221, v144, v197
    v_fma_f32 v144, v220, v144, v136
    v_fma_f32 v145, v220, v145, v137
    v_fma_f32 v136, -v221, v145, v198
    v_fma_f32 v137, v221, v144, v199
    v_fma_f32 v144, v220, v144, v136
    v_fma_f32 v145, v220, v145, v137
    v_fma_f32 v136, -v221, v145, v200
    v_fma_f32 v137, v221, v144, v201
    v_fma_f32 v144, v220, v144, v136
    v_fma_f32 v145, v220, v145, v137
    v_fma_f32 v136, -v221, v145, v202
    v_fma_f32 v137, v221, v144, v203
    v_fma_f32 v144, v220, v144, v136
    v_fma_f32 v145, v220, v145, v137
    v_fma_f32 v136, -v221, v145, v204
    v_fma_f32 v137, v221, v144, v205
    v_fma_f32 v144, v220, v144, v136
    v_fma_f32 v145, v220, v145, v137
    v_fma_f32 v136, -v221, v145, v206
    v_fma_f32 v137, v221, v144, v207
    v_fma_f32 v144, v220, v144, v136
    v_fma_f32 v145, v220, v145, v137
    v_mov_b32 v148, v144
    v_mov_b32 v149, s85
    v_mov_b32 v150, v145
    v_mov_b32 v151, s85
    buffer_store_dwordx4 v[148:151], v26, s[24:27], s48 offen sc1
    s_mov_b32 s71, 400000
    v_mul_f32 v132, v211, v64
    v_mul_f32 v133, v211, v32
    v_fma_f32 v32, v210, v32, -v132
    v_fma_f32 v64, -v210, v64, -v133
    v_mul_f32 v134, v215, v80
    v_mul_f32 v135, v215, v48
    v_fma_f32 v48, v214, v48, -v134
    v_fma_f32 v80, -v214, v80, -v135
    v_mul_f32 v132, v211, v65
    v_mul_f32 v133, v211, v33
    v_fma_f32 v33, v210, v33, -v132
    v_fma_f32 v65, -v210, v65, -v133
    v_mul_f32 v134, v215, v81
    v_mul_f32 v135, v215, v49
    v_fma_f32 v49, v214, v49, -v134
    v_fma_f32 v81, -v214, v81, -v135
    v_mul_f32 v132, v211, v66
    v_mul_f32 v133, v211, v34
    v_fma_f32 v34, v210, v34, -v132
    v_fma_f32 v66, -v210, v66, -v133
    v_mul_f32 v134, v215, v82
    v_mul_f32 v135, v215, v50
    v_fma_f32 v50, v214, v50, -v134
    v_fma_f32 v82, -v214, v82, -v135
    v_mul_f32 v132, v211, v67
    v_mul_f32 v133, v211, v35
    v_fma_f32 v35, v210, v35, -v132
    v_fma_f32 v67, -v210, v67, -v133
    v_mul_f32 v134, v215, v83
    v_mul_f32 v135, v215, v51
    v_fma_f32 v51, v214, v51, -v134
    v_fma_f32 v83, -v214, v83, -v135
    v_mul_f32 v132, v211, v68
    v_mul_f32 v133, v211, v36
    v_fma_f32 v36, v210, v36, -v132
    v_fma_f32 v68, -v210, v68, -v133
    v_mul_f32 v134, v215, v84
    v_mul_f32 v135, v215, v52
    v_fma_f32 v52, v214, v52, -v134
    v_fma_f32 v84, -v214, v84, -v135
    v_mul_f32 v132, v211, v69
    v_mul_f32 v133, v211, v37
    v_fma_f32 v37, v210, v37, -v132
    v_fma_f32 v69, -v210, v69, -v133
    v_mul_f32 v134, v215, v85
    v_mul_f32 v135, v215, v53
    v_fma_f32 v53, v214, v53, -v134
    v_fma_f32 v85, -v214, v85, -v135
    v_mul_f32 v132, v211, v70
    v_mul_f32 v133, v211, v38
    v_fma_f32 v38, v210, v38, -v132
    v_fma_f32 v70, -v210, v70, -v133
    v_mul_f32 v134, v215, v86
    v_mul_f32 v135, v215, v54
    v_fma_f32 v54, v214, v54, -v134
    v_fma_f32 v86, -v214, v86, -v135
    v_mul_f32 v132, v211, v71
    v_mul_f32 v133, v211, v39
    v_fma_f32 v39, v210, v39, -v132
    v_fma_f32 v71, -v210, v71, -v133
    v_mul_f32 v134, v215, v87
    v_mul_f32 v135, v215, v55
    v_fma_f32 v55, v214, v55, -v134
    v_fma_f32 v87, -v214, v87, -v135
    v_mul_f32 v132, v211, v72
    v_mul_f32 v133, v211, v40
    v_fma_f32 v40, v210, v40, -v132
    v_fma_f32 v72, -v210, v72, -v133
    v_mul_f32 v134, v215, v88
    v_mul_f32 v135, v215, v56
    v_fma_f32 v56, v214, v56, -v134
    v_fma_f32 v88, -v214, v88, -v135
    v_mul_f32 v132, v211, v73
    v_mul_f32 v133, v211, v41
    v_fma_f32 v41, v210, v41, -v132
    v_fma_f32 v73, -v210, v73, -v133
    v_mul_f32 v134, v215, v89
    v_mul_f32 v135, v215, v57
    v_fma_f32 v57, v214, v57, -v134
    v_fma_f32 v89, -v214, v89, -v135
    v_mul_f32 v132, v211, v74
    v_mul_f32 v133, v211, v42
    v_fma_f32 v42, v210, v42, -v132
    v_fma_f32 v74, -v210, v74, -v133
    v_mul_f32 v134, v215, v90
    v_mul_f32 v135, v215, v58
    v_fma_f32 v58, v214, v58, -v134
    v_fma_f32 v90, -v214, v90, -v135
    v_mul_f32 v132, v211, v75
    v_mul_f32 v133, v211, v43
    v_fma_f32 v43, v210, v43, -v132
    v_fma_f32 v75, -v210, v75, -v133
    v_mul_f32 v134, v215, v91
    v_mul_f32 v135, v215, v59
    v_fma_f32 v59, v214, v59, -v134
    v_fma_f32 v91, -v214, v91, -v135
    v_mul_f32 v132, v211, v76
    v_mul_f32 v133, v211, v44
    v_fma_f32 v44, v210, v44, -v132
    v_fma_f32 v76, -v210, v76, -v133
    v_mul_f32 v134, v215, v92
    v_mul_f32 v135, v215, v60
    v_fma_f32 v60, v214, v60, -v134
    v_fma_f32 v92, -v214, v92, -v135
    v_mul_f32 v132, v211, v77
    v_mul_f32 v133, v211, v45
    v_fma_f32 v45, v210, v45, -v132
    v_fma_f32 v77, -v210, v77, -v133
    v_mul_f32 v134, v215, v93
    v_mul_f32 v135, v215, v61
    v_fma_f32 v61, v214, v61, -v134
    v_fma_f32 v93, -v214, v93, -v135
    v_mul_f32 v132, v211, v78
    v_mul_f32 v133, v211, v46
    v_fma_f32 v46, v210, v46, -v132
    v_fma_f32 v78, -v210, v78, -v133
    v_mul_f32 v134, v215, v94
    v_mul_f32 v135, v215, v62
    v_fma_f32 v62, v214, v62, -v134
    v_fma_f32 v94, -v214, v94, -v135
    v_mul_f32 v132, v211, v79
    v_mul_f32 v133, v211, v47
    v_fma_f32 v47, v210, v47, -v132
    v_fma_f32 v79, -v210, v79, -v133
    v_mul_f32 v134, v215, v95
    v_mul_f32 v135, v215, v63
    v_fma_f32 v63, v214, v63, -v134
    v_fma_f32 v95, -v214, v95, -v135
k1s_poll:
    buffer_load_dwordx4 v[224:227], v26, s[24:27], s66 offen offset:0 sc1
    buffer_load_dwordx4 v[228:231], v26, s[24:27], s66 offen offset:1024 sc1
    buffer_load_dwordx4 v[232:235], v26, s[24:27], s66 offen offset:2048 sc1
    buffer_load_dwordx4 v[236:239], v26, s[24:27], s66 offen offset:3072 sc1
    buffer_load_dwordx4 v[240:243], v26, s[24:27], s67 offen offset:0 sc1
    buffer_load_dwordx4 v[244:247], v26, s[24:27], s67 offen offset:1024 sc1
    buffer_load_dwordx4 v[248:251], v26, s[24:27], s67 offen offset:2048 sc1
    v_mov_b32 v144, 0
    v_mov_b32 v145, 0
    s_sub_u32 s71, s71, 1
    s_waitcnt vmcnt(0)
    s_cmp_eq_u32 s71, 0
    s_cbranch_scc1 k1s_carry
    s_cmp_le_u32 s4, 0
    s_cbranch_scc1 k1s_carry
    v_cmp_ne_u32 vcc, s85, v225
    v_cmp_ne_u32 s[48:49], s85, v227
    v_fma_f32 v136, -v223, v145, v224
    v_fma_f32 v137, v223, v144, v226
    v_fma_f32 v144, v222, v144, v136
    v_fma_f32 v145, v222, v145, v137
    s_or_b64 vcc, vcc, s[48:49]
    s_cbranch_scc1 k1s_poll
    s_cmp_le_u32 s4, 1
    s_cbranch_scc1 k1s_carry
    v_cmp_ne_u32 vcc, s85, v229
    v_cmp_ne_u32 s[48:49], s85, v231
    v_fma_f32 v136, -v223, v145, v228
    v_fma_f32 v137, v223, v144, v230
    v_fma_f32 v144, v222, v144, v136
    v_fma_f32 v145, v222, v145, v137
    s_or_b64 vcc, vcc, s[48:49]
    s_cbranch_scc1 k1s_poll
    s_cmp_le_u32 s4, 2
    s_cbranch_scc1 k1s_carry
    v_cmp_ne_u32 vcc, s85, v233
    v_cmp_ne_u32 s[48:49], s85, v235
    v_fma_f32 v136, -v223, v145, v232
    v_fma_f32 v137, v223, v144, v234
    v_fma_f32 v144, v222, v144, v136
    v_fma_f32 v145, v222, v145, v137
    s_or_b64 vcc, vcc, s[48:49]
    s_cbranch_scc1 k1s_poll
    s_cmp_le_u32 s4, 3
    s_cbranch_scc1 k1s_carry
    v_cmp_ne_u32 vcc, s85, v237
    v_cmp_ne_u32 s[48:49], s85, v239
    v_fma_f32 v136, -v223, v145, v236
    v_fma_f32 v137, v223, v144, v238
    v_fma_f32 v144, v222, v144, v136
    v_fma_f32 v145, v222, v145, v137
    s_or_b64 vcc, vcc, s[48:49]
    s_cbranch_scc1 k1s_poll
    s_cmp_le_u32 s4, 4
    s_cbranch_scc1 k1s_carry
    v_cmp_ne_u32 vcc, s85, v241
    v_cmp_ne_u32 s[48:49], s85, v243
    v_fma_f32 v136, -v223, v145, v240
    v_fma_f32 v137, v223, v144, v242
    v_fma_f32 v144, v222, v144, v136
    v_fma_f32 v145, v222, v145, v137
    s_or_b64 vcc, vcc, s[48:49]
    s_cbranch_scc1 k1s_poll
    s_cmp_le_u32 s4, 5
    s_cbranch_scc1 k1s_carry
    v_cmp_ne_u32 vcc, s85, v245
    v_cmp_ne_u32 s[48:49], s85, v247
    v_fma_f32 v136, -v223, v145, v244
    v_fma_f32 v137, v223, v144, v246
    v_fma_f32 v144, v222, v144, v136
    v_fma_f32 v145, v222, v145, v137
    s_or_b64 vcc, vcc, s[48:49]
    s_cbranch_scc1 k1s_poll
    s_cmp_le_u32 s4, 6
    s_cbranch_scc1 k1s_carry
    v_cmp_ne_u32 vcc, s85, v249
    v_cmp_ne_u32 s[48:49], s85, v251
    v_fma_f32 v136, -v223, v145, v248
    v_fma_f32 v137, v223, v144, v250
    v_fma_f32 v144, v222, v144, v136
    v_fma_f32 v145, v222, v145, v137
    s_or_b64 vcc, vcc, s[48:49]
    s_cbranch_scc1 k1s_poll
k1s_carry:
    ds_write_b64 v28, v[144:145] offset:8192
    v_fma_f32 v136, -v221, v145, v176
    v_fma_f32 v137, v221, v144, v177
    v_fma_f32 v146, v220, v144, v136
    v_fma_f32 v147, v220, v145, v137
    ds_write_b64 v28, v[146:147] offset:8704
    v_fma_f32 v136, -v221, v147, v178
    v_fma_f32 v137, v221, v146, v179
    v_fma_f32 v144, v220, v146, v136
    v_fma_f32 v145, v220, v147, v137
    ds_write_b64 v28, v[144:145] offset:9216
    v_fma_f32 v136, -v221, v145, v180
    v_fma_f32 v137, v221, v144, v181
    v_fma_f32 v146, v220, v144, v136
    v_fma_f32 v147, v220, v145, v137
    ds_write_b64 v28, v[146:147] offset:9728
    v_fma_f32 v136, -v221, v147, v182
    v_fma_f32 v137, v221, v146, v183
    v_fma_f32 v144, v220, v146, v136
    v_fma_f32 v145, v220, v147, v137
    ds_write_b64 v28, v[144:145] offset:10240
    v_fma_f32 v136, -v221, v145, v184
    v_fma_f32 v137, v221, v144, v185
    v_fma_f32 v146, v220, v144, v136
    v_fma_f32 v147, v220, v145, v137
    ds_write_b64 v28, v[146:147] offset:10752
    v_fma_f32 v136, -v221, v147, v186
    v_fma_f32 v137, v221, v146, v187
    v_fma_f32 v144, v220, v146, v136
    v_fma_f32 v145, v220, v147, v137
    ds_write_b64 v28, v[144:145] offset:11264
    v_fma_f32 v136, -v221, v145, v188
    v_fma_f32 v137, v221, v144, v189
    v_fma_f32 v146, v220, v144, v136
    v_fma_f32 v147, v220, v145, v137
    ds_write_b64 v28, v[146:147] offset:11776
    v_fma_f32 v136, -v221, v147, v190
    v_fma_f32 v137, v221, v146, v191
    v_fma_f32 v144, v220, v146, v136
    v_fma_f32 v145, v220, v147, v137
    ds_write_b64 v28, v[144:145] offset:12288
    v_fma_f32 v136, -v221, v145, v192
    v_fma_f32 v137, v221, v144, v193
    v_fma_f32 v146, v220, v144, v136
    v_fma_f32 v147, v220, v145, v137
    ds_write_b64 v28, v[146:147] offset:12800
    v_fma_f32 v136, -v221, v147, v194
    v_fma_f32 v137, v221, v146, v195
    v_fma_f32 v144, v220, v146, v136
    v_fma_f32 v145, v220, v147, v137
    ds_write_b64 v28, v[144:145] offset:13312
    v_fma_f32 v136, -v221, v145, v196
    v_fma_f32 v137, v221, v144, v197
    v_fma_f32 v146, v220, v144, v136
    v_fma_f32 v147, v220, v145, v137
    ds_write_b64 v28, v[146:147] offset:13824
    v_fma_f32 v136, -v221, v147, v198
    v_fma_f32 v137, v221, v146, v199
    v_fma_f32 v144, v220, v146, v136
    v_fma_f32 v145, v220, v147, v137
    ds_write_b64 v28, v[144:145] offset:14336
    v_fma_f32 v136, -v221, v145, v200
    v_fma_f32 v137, v221, v144, v201
    v_fma_f32 v146, v220, v144, v136
    v_fma_f32 v147, v220, v145, v137
    ds_write_b64 v28, v[146:147] offset:14848
    v_fma_f32 v136, -v221, v147, v202
    v_fma_f32 v137, v221, v146, v203
    v_fma_f32 v144, v220, v146, v136
    v_fma_f32 v145, v220, v147, v137
    ds_write_b64 v28, v[144:145] offset:15360
    v_fma_f32 v136, -v221, v145, v204
    v_fma_f32 v137, v221, v144, v205
    v_fma_f32 v146, v220, v144, v136
    v_fma_f32 v147, v220, v145, v137
    ds_write_b64 v28, v[146:147] offset:15872
    s_waitcnt lgkmcnt(0)
k1s_join:
    s_barrier
    ds_read_b64 v[128:129], v24 offset:8192
    ds_read_b64 v[130:131], v24 offset:8320
    s_lshl_b32 s48, s5, 14
    s_add_u32 s64, s64, s48
    s_lshl_b32 s48, s7, 13
    s_add_u32 s64, s64, s48
    s_add_u32 s65, s64, 262144
    v_bfe_u32 v25, v2, 2, 1
    v_lshlrev_b32 v25, 3, v25
    v_bfe_u32 v26, v2, 3, 1
    v_lshl_add_u32 v25, v26, 2, v25
    v_add_u32 v25, v25, v10
    v_lshlrev_b32 v25, 4, v25
    v_lshl_add_u32 v25, v3, 10, v25
    v_xor_b32 v26, 0x280, v25
    s_mov_b32 s72, 0
    s_bfe_u32 s73, s2, 0x20001
    s_lshl_b32 s73, s73, 2
    s_bfe_u32 s74, s2, 0x20003
    s_add_u32 s73, s73, s74
    s_and_b32 s74, s2, 1
    s_lshl_b32 s74, s74, 2
    s_bfe_u32 s75, s2, 0x20005
    s_add_u32 s74, s74, s75
    s_lshr_b32 s75, s3, 2
    s_bfe_u32 s76, s3, 0x10001
    s_and_b32 s77, s3, 1
    v_lshrrev_b32 v8, 3, v1
    v_and_b32 v7, 7, v1
    s_mov_b32 s12, s88
    s_and_b32 s13, s89, 0xffff
    s_mov_b32 s14, 0x200000
    s_mov_b32 s15, 0x20000
    s_lshl_b32 s48, s74, 7
    s_lshl_b32 s49, s3, 4
    s_add_u32 s48, s48, s49
    v_xor_b32 v5, v7, v8
    v_lshlrev_b32 v5, 4, v5
    v_add_u32 v6, s48, v8
    v_lshl_add_u32 v5, v6, 11, v5
    v_add_u32 v6, 16384, v5
    s_lshl_b32 s52, s3, 11
    s_add_u32 s60, s52, 16384
    s_add_u32 s61, s60, 1024
    s_mov_b32 s55, 0
    s_movk_i32 s56, 128
    s_mov_b32 s50, 0
    s_add_u32 m0, s50, s60
    s_nop 0
    buffer_load_dwordx4 v5, s[12:15], s55 offen lds
    s_add_u32 m0, s50, s61
    s_nop 0
    buffer_load_dwordx4 v6, s[12:15], s55 offen lds
    s_add_u32 s55, s55, s56
    s_mov_b32 s50, 32768
    s_add_u32 m0, s50, s60
    s_nop 0
    buffer_load_dwordx4 v5, s[12:15], s55 offen lds
    s_add_u32 m0, s50, s61
    s_nop 0
    buffer_load_dwordx4 v6, s[12:15], s55 offen lds
    s_add_u32 s55, s55, s56
    s_mov_b32 s50, 65536
    s_add_u32 m0, s50, s60
    s_nop 0
    buffer_load_dwordx4 v5, s[12:15], s55 offen lds
    s_add_u32 m0, s50, s61
    s_nop 0
    buffer_load_dwordx4 v6, s[12:15], s55 offen lds
    s_add_u32 s55, s55, s56
    s_mov_b32 s50, 98304
    s_add_u32 m0, s50, s60
    s_nop 0
    buffer_load_dwordx4 v5, s[12:15], s55 offen lds
    s_add_u32 m0, s50, s61
    s_nop 0
    buffer_load_dwordx4 v6, s[12:15], s55 offen lds
    s_add_u32 s55, s55, s56
    s_mov_b32 s50, 131072
    s_add_u32 m0, s50, s60
    s_nop 0
    buffer_load_dwordx4 v5, s[12:15], s55 offen lds
    s_add_u32 m0, s50, s61
    s_nop 0
    buffer_load_dwordx4 v6, s[12:15], s55 offen lds
    s_add_u32 s55, s55, s56
    s_mov_b32 s34, 13
    s_mov_b32 s35, 17
    s_mov_b32 s36, 20
    s_mov_b32 s37, 43
    s_mov_b32 s38, 46
    s_mov_b32 s39, 11
    s_mov_b32 s53, 1000
    s_mov_b32 s45, 0
    s_mov_b32 s80, 15
    s_mov_b32 s81, 255
    s_mov_b32 s82, 23
    s_mov_b32 s83, 27
    s_mul_i32 s54, s73, 1441792
    s_add_u32 s62, s54, 524288
    s_waitcnt lgkmcnt(0)
    v_mul_f32 v136, v211, v129
    v_mul_f32 v137, v211, v128
    v_fma_f32 v136, v210, v128, -v136
    v_fma_f32 v137, v210, v129, v137
    v_mul_f32 v138, v111, v137
    v_mul_f32 v139, v111, v136
    v_fma_f32 v138, v110, v136, -v138
    v_fma_f32 v139, v110, v137, v139
    v_mul_f32 v140, v215, v131
    v_mul_f32 v141, v215, v130
    v_fma_f32 v140, v214, v130, -v140
    v_fma_f32 v141, v214, v131, v141
    v_mul_f32 v142, v127, v141
    v_mul_f32 v143, v127, v140
    v_fma_f32 v142, v126, v140, -v142
    v_fma_f32 v143, v126, v141, v143
    v_fma_f32 v32, v96, v136, v32
    v_fma_f32 v64, -v96, v137, v64
    v_fma_f32 v48, v112, v140, v48
    v_fma_f32 v80, -v112, v141, v80
    v_fma_f32 v32, -v97, v137, v32
    v_fma_f32 v64, -v97, v136, v64
    v_fma_f32 v48, -v113, v141, v48
    v_fma_f32 v80, -v113, v140, v80
    v_fma_f32 v33, v98, v136, v33
    v_fma_f32 v65, -v98, v137, v65
    v_fma_f32 v49, v114, v140, v49
    v_fma_f32 v81, -v114, v141, v81
    v_fma_f32 v33, -v99, v137, v33
    v_fma_f32 v65, -v99, v136, v65
    v_fma_f32 v49, -v115, v141, v49
    v_fma_f32 v81, -v115, v140, v81
    v_fma_f32 v34, v100, v136, v34
    v_fma_f32 v66, -v100, v137, v66
    v_fma_f32 v50, v116, v140, v50
    v_fma_f32 v82, -v116, v141, v82
    v_fma_f32 v34, -v101, v137, v34
    v_fma_f32 v66, -v101, v136, v66
    v_fma_f32 v50, -v117, v141, v50
    v_fma_f32 v82, -v117, v140, v82
    v_fma_f32 v35, v102, v136, v35
    v_fma_f32 v67, -v102, v137, v67
    v_fma_f32 v51, v118, v140, v51
    v_fma_f32 v83, -v118, v141, v83
    v_fma_f32 v35, -v103, v137, v35
    v_fma_f32 v67, -v103, v136, v67
    v_fma_f32 v51, -v119, v141, v51
    v_fma_f32 v83, -v119, v140, v83
    v_fma_f32 v36, v104, v136, v36
    v_fma_f32 v68, -v104, v137, v68
    v_fma_f32 v52, v120, v140, v52
    v_fma_f32 v84, -v120, v141, v84
    v_fma_f32 v36, -v105, v137, v36
    v_fma_f32 v68, -v105, v136, v68
    v_fma_f32 v52, -v121, v141, v52
    v_fma_f32 v84, -v121, v140, v84
    v_fma_f32 v37, v106, v136, v37
    v_fma_f32 v69, -v106, v137, v69
    v_fma_f32 v53, v122, v140, v53
    v_fma_f32 v85, -v122, v141, v85
    v_fma_f32 v37, -v107, v137, v37
    v_fma_f32 v69, -v107, v136, v69
    v_fma_f32 v53, -v123, v141, v53
    v_fma_f32 v85, -v123, v140, v85
    v_fma_f32 v38, v108, v136, v38
    v_fma_f32 v70, -v108, v137, v70
    v_fma_f32 v54, v124, v140, v54
    v_fma_f32 v86, -v124, v141, v86
    v_fma_f32 v38, -v109, v137, v38
    v_fma_f32 v70, -v109, v136, v70
    v_fma_f32 v54, -v125, v141, v54
    v_fma_f32 v86, -v125, v140, v86
    v_fma_f32 v39, v110, v136, v39
    v_fma_f32 v71, -v110, v137, v71
    v_fma_f32 v55, v126, v140, v55
    v_fma_f32 v87, -v126, v141, v87
    v_fma_f32 v39, -v111, v137, v39
    v_fma_f32 v71, -v111, v136, v71
    v_fma_f32 v55, -v127, v141, v55
    v_fma_f32 v87, -v127, v140, v87
    v_cvt_pk_bf16_f32 v168, v32, v33
    v_cvt_pk_bf16_f32 v169, v34, v35
    v_cvt_pk_bf16_f32 v170, v36, v37
    v_cvt_pk_bf16_f32 v171, v38, v39
    buffer_store_dwordx4 v[168:171], v25, s[24:27], s64 offen offset:0 sc1
    v_cvt_pk_bf16_f32 v172, v64, v65
    v_cvt_pk_bf16_f32 v173, v66, v67
    v_cvt_pk_bf16_f32 v174, v68, v69
    v_cvt_pk_bf16_f32 v175, v70, v71
    buffer_store_dwordx4 v[172:175], v25, s[24:27], s65 offen offset:0 sc1
    v_cvt_pk_bf16_f32 v176, v48, v49
    v_cvt_pk_bf16_f32 v177, v50, v51
    v_cvt_pk_bf16_f32 v178, v52, v53
    v_cvt_pk_bf16_f32 v179, v54, v55
    buffer_store_dwordx4 v[176:179], v25, s[24:27], s64 offen offset:256 sc1
    v_cvt_pk_bf16_f32 v180, v80, v81
    v_cvt_pk_bf16_f32 v181, v82, v83
    v_cvt_pk_bf16_f32 v182, v84, v85
    v_cvt_pk_bf16_f32 v183, v86, v87
    buffer_store_dwordx4 v[180:183], v25, s[24:27], s65 offen offset:256 sc1
    v_fma_f32 v40, v96, v138, v40
    v_fma_f32 v72, -v96, v139, v72
    v_fma_f32 v56, v112, v142, v56
    v_fma_f32 v88, -v112, v143, v88
    v_fma_f32 v40, -v97, v139, v40
    v_fma_f32 v72, -v97, v138, v72
    v_fma_f32 v56, -v113, v143, v56
    v_fma_f32 v88, -v113, v142, v88
    v_fma_f32 v41, v98, v138, v41
    v_fma_f32 v73, -v98, v139, v73
    v_fma_f32 v57, v114, v142, v57
    v_fma_f32 v89, -v114, v143, v89
    v_fma_f32 v41, -v99, v139, v41
    v_fma_f32 v73, -v99, v138, v73
    v_fma_f32 v57, -v115, v143, v57
    v_fma_f32 v89, -v115, v142, v89
    v_fma_f32 v42, v100, v138, v42
    v_fma_f32 v74, -v100, v139, v74
    v_fma_f32 v58, v116, v142, v58
    v_fma_f32 v90, -v116, v143, v90
    v_fma_f32 v42, -v101, v139, v42
    v_fma_f32 v74, -v101, v138, v74
    v_fma_f32 v58, -v117, v143, v58
    v_fma_f32 v90, -v117, v142, v90
    v_fma_f32 v43, v102, v138, v43
    v_fma_f32 v75, -v102, v139, v75
    v_fma_f32 v59, v118, v142, v59
    v_fma_f32 v91, -v118, v143, v91
    v_fma_f32 v43, -v103, v139, v43
    v_fma_f32 v75, -v103, v138, v75
    v_fma_f32 v59, -v119, v143, v59
    v_fma_f32 v91, -v119, v142, v91
    v_fma_f32 v44, v104, v138, v44
    v_fma_f32 v76, -v104, v139, v76
    v_fma_f32 v60, v120, v142, v60
    v_fma_f32 v92, -v120, v143, v92
    v_fma_f32 v44, -v105, v139, v44
    v_fma_f32 v76, -v105, v138, v76
    v_fma_f32 v60, -v121, v143, v60
    v_fma_f32 v92, -v121, v142, v92
    v_fma_f32 v45, v106, v138, v45
    v_fma_f32 v77, -v106, v139, v77
    v_fma_f32 v61, v122, v142, v61
    v_fma_f32 v93, -v122, v143, v93
    v_fma_f32 v45, -v107, v139, v45
    v_fma_f32 v77, -v107, v138, v77
    v_fma_f32 v61, -v123, v143, v61
    v_fma_f32 v93, -v123, v142, v93
    v_fma_f32 v46, v108, v138, v46
    v_fma_f32 v78, -v108, v139, v78
    v_fma_f32 v62, v124, v142, v62
    v_fma_f32 v94, -v124, v143, v94
    v_fma_f32 v46, -v109, v139, v46
    v_fma_f32 v78, -v109, v138, v78
    v_fma_f32 v62, -v125, v143, v62
    v_fma_f32 v94, -v125, v142, v94
    v_fma_f32 v47, v110, v138, v47
    v_fma_f32 v79, -v110, v139, v79
    v_fma_f32 v63, v126, v142, v63
    v_fma_f32 v95, -v126, v143, v95
    v_fma_f32 v47, -v111, v139, v47
    v_fma_f32 v79, -v111, v138, v79
    v_fma_f32 v63, -v127, v143, v63
    v_fma_f32 v95, -v127, v142, v95
    v_cvt_pk_bf16_f32 v184, v40, v41
    v_cvt_pk_bf16_f32 v185, v42, v43
    v_cvt_pk_bf16_f32 v186, v44, v45
    v_cvt_pk_bf16_f32 v187, v46, v47
    buffer_store_dwordx4 v[184:187], v26, s[24:27], s64 offen offset:0 sc1
    v_cvt_pk_bf16_f32 v188, v72, v73
    v_cvt_pk_bf16_f32 v189, v74, v75
    v_cvt_pk_bf16_f32 v190, v76, v77
    v_cvt_pk_bf16_f32 v191, v78, v79
    buffer_store_dwordx4 v[188:191], v26, s[24:27], s65 offen offset:0 sc1
    v_cvt_pk_bf16_f32 v192, v56, v57
    v_cvt_pk_bf16_f32 v193, v58, v59
    v_cvt_pk_bf16_f32 v194, v60, v61
    v_cvt_pk_bf16_f32 v195, v62, v63
    buffer_store_dwordx4 v[192:195], v26, s[24:27], s64 offen offset:256 sc1
    v_cvt_pk_bf16_f32 v196, v88, v89
    v_cvt_pk_bf16_f32 v197, v90, v91
    v_cvt_pk_bf16_f32 v198, v92, v93
    v_cvt_pk_bf16_f32 v199, v94, v95
    buffer_store_dwordx4 v[196:199], v26, s[24:27], s65 offen offset:256 sc1
    s_mov_b32 s84, s70
    s_mov_b32 s20, s28
    s_and_b32 s21, s29, 0xffff
    s_mov_b32 s22, 0x400000
    s_mov_b32 s23, 0x20000
    s_mov_b32 s64, s92
    s_and_b32 s65, s93, 0xffff
    s_mov_b32 s66, 0x800
    s_mov_b32 s67, 0x20000
    s_mov_b32 s68, s86
    s_and_b32 s69, s87, 0xffff
    s_mov_b32 s70, 0x800000
    s_mov_b32 s71, 0x20000
    s_mov_b32 s16, s94
    s_and_b32 s17, s95, 0xffff
    s_mov_b32 s18, 0x700000
    s_mov_b32 s19, 0x20000
    v_bfe_u32 v9, v1, 2, 2
    v_and_b32 v10, 3, v1
    s_lshl_b32 s48, s3, 3
    v_add_u32 v11, s48, v8
    v_lshlrev_b32 v11, 11, v11
    v_lshlrev_b32 v12, 1, v3
    v_xor_b32 v12, v12, v7
    v_lshl_add_u32 v11, v12, 4, v11
    s_lshl_b32 s48, s74, 8
    v_add_u32 v11, s48, v11
    v_add_u32 v12, 128, v11
    s_lshl_b32 s63, s3, 10
    s_add_u32 s63, s63, 16384
    s_lshl_b32 s48, s75, 13
    s_lshl_b32 s49, s76, 12
    s_add_u32 s48, s48, s49
    v_lshrrev_b32 v21, 1, v3
    v_lshlrev_b32 v21, 4, v21
    v_lshrrev_b32 v22, 1, v10
    v_lshl_add_u32 v21, v22, 3, v21
    v_and_b32 v23, 1, v3
    v_lshl_add_u32 v21, v23, 2, v21
    v_add_u32 v21, v21, v9
    v_lshlrev_b32 v13, 4, v21
    v_lshl_add_u32 v13, v22, 9, v13
    v_and_b32 v22, 1, v10
    v_lshl_add_u32 v13, v22, 3, v13
    v_add_u32 v13, s48, v13
    v_xor_b32 v14, 128, v13
    v_lshlrev_b32 v16, 4, v1
    v_add_u32 v16, s48, v16
    s_lshl_b32 s48, s75, 2
    v_add_u32 v15, s48, v3
    v_xor_b32 v15, v15, v7
    v_lshlrev_b32 v15, 4, v15
    v_lshl_add_u32 v15, v2, 7, v15
    s_lshl_b32 s48, s77, 13
    s_add_u32 s48, s48, 16384
    v_add_u32 v15, s48, v15
    s_lshl_b32 s49, s75, 12
    s_add_u32 s48, s48, s49
    v_lshl_add_u32 v21, v3, 2, v9
    v_lshlrev_b32 v21, 7, v21
    v_lshl_add_u32 v21, v10, 3, v21
    v_add_u32 v21, s48, v21
    v_lshlrev_b32 v22, 1, v23
    v_lshrrev_b32 v23, 1, v9
    v_add_u32 v22, v22, v23
    v_xor_b32 v23, 0, v22
    v_lshl_add_u32 v17, v23, 5, v21
    v_xor_b32 v23, 1, v22
    v_lshl_add_u32 v18, v23, 5, v21
    v_xor_b32 v23, 2, v22
    v_lshl_add_u32 v19, v23, 5, v21
    v_xor_b32 v23, 3, v22
    v_lshl_add_u32 v20, v23, 5, v21
    v_mov_b64 v[32:33], 0
    v_mov_b64 v[34:35], 0
    v_mov_b64 v[36:37], 0
    v_mov_b64 v[38:39], 0
    v_mov_b64 v[40:41], 0
    v_mov_b64 v[42:43], 0
    v_mov_b64 v[44:45], 0
    v_mov_b64 v[46:47], 0
    v_mov_b64 v[48:49], 0
    v_mov_b64 v[50:51], 0
    v_mov_b64 v[52:53], 0
    v_mov_b64 v[54:55], 0
    v_mov_b64 v[56:57], 0
    v_mov_b64 v[58:59], 0
    v_mov_b64 v[60:61], 0
    v_mov_b64 v[62:63], 0
    v_mov_b64 v[64:65], 0
    v_mov_b64 v[66:67], 0
    v_mov_b64 v[68:69], 0
    v_mov_b64 v[70:71], 0
    v_mov_b64 v[72:73], 0
    v_mov_b64 v[74:75], 0
    v_mov_b64 v[76:77], 0
    v_mov_b64 v[78:79], 0
    v_mov_b64 v[80:81], 0
    v_mov_b64 v[82:83], 0
    v_mov_b64 v[84:85], 0
    v_mov_b64 v[86:87], 0
    v_mov_b64 v[88:89], 0
    v_mov_b64 v[90:91], 0
    v_mov_b64 v[92:93], 0
    v_mov_b64 v[94:95], 0
    s_lshl_b32 s78, s73, 7
    s_lshl_b32 s48, s76, 6
    s_add_u32 s78, s78, s48
    s_lshl_b32 s40, s78, 2
    s_add_u32 s40, s40, 25165824
    s_lshl_b32 s49, s75, 7
    s_add_u32 s41, s40, s49
    s_lshl_b32 s49, s75, 5
    s_add_u32 s78, s78, s49
    s_lshl_b32 s79, s74, 7
    s_lshl_b32 s48, s77, 6
    s_add_u32 s79, s79, s48
    s_lshl_b32 s48, s72, 5
    s_add_u32 s79, s79, s48
    s_lshl_b32 s42, s78, 11
    s_lshl_b32 s44, s79, 1
    s_add_u32 s42, s42, s44
    s_add_u32 s43, s42, 32768
    v_mov_b32 v24, v13
    v_mov_b32 v25, v14
    v_mov_b32 v26, v15
    s_waitcnt vmcnt(0)
    s_barrier
    s_cmp_lg_u32 s3, 0
    s_cbranch_scc1 k1s_nf
    v_mov_b32 v30, s85
    s_mov_b64 exec, 1
    buffer_store_dword v30, v31, s[24:27], s84 offen sc1
    s_mov_b64 exec, -1
k1s_nf:
    s_mov_b32 s8, s46
    s_and_b32 s9, s47, 0xffff
    s_mov_b32 s10, 0x10000000
    s_mov_b32 s11, 0x20000
    v_lshlrev_b32 v29, 7, v1
    s_lshr_b32 s48, s73, 1
    s_lshl_b32 s48, s48, 12
    s_add_u32 s57, s48, 25427968
    s_add_u32 s48, s48, 25493504
    v_lshlrev_b32 v4, 4, v1
    v_add_u32 v4, s52, v4
    s_cmp_lg_u32 s3, 0
    s_cbranch_scc1 k2_fbars
    s_mov_b32 s59, 400000
    s_mov_b64 exec, 0xffff
k2_fpolls:
    buffer_load_dword v30, v29, s[24:27], s48 offen sc1
    s_sub_u32 s59, s59, 1
    s_waitcnt vmcnt(0)
    v_cmp_ne_u32 vcc, s85, v30
    s_cmp_eq_u32 s59, 0
    s_cbranch_scc1 k2_foks
    s_nop 2
    s_cbranch_vccz k2_foks
    s_branch k2_fpolls
k2_foks:
    s_mov_b64 exec, -1
k2_fbars:
    v_mov_b32 v30, 0
    s_barrier
    s_add_u32 m0, s52, 0
    s_nop 0
    buffer_load_dwordx4 v4, s[8:11], s54 offen sc1 lds
    buffer_load_dwordx4 v4, s[8:11], s54 offen offset:1024 sc1 lds
    s_add_u32 s54, s54, 16384
    s_add_u32 m0, s52, 32768
    s_nop 0
    buffer_load_dwordx4 v4, s[8:11], s54 offen sc1 lds
    buffer_load_dwordx4 v4, s[8:11], s54 offen offset:1024 sc1 lds
    s_add_u32 s54, s54, 16384
    s_add_u32 m0, s52, 65536
    s_nop 0
    buffer_load_dwordx4 v4, s[8:11], s54 offen sc1 lds
    buffer_load_dwordx4 v4, s[8:11], s54 offen offset:1024 sc1 lds
    s_add_u32 s54, s54, 16384
    s_add_u32 m0, s52, 98304
    s_nop 0
    buffer_load_dwordx4 v4, s[8:11], s54 offen sc1 lds
    buffer_load_dwordx4 v4, s[8:11], s54 offen offset:1024 sc1 lds
    s_add_u32 s54, s54, 16384
    s_add_u32 m0, s52, 131072
    s_nop 0
    buffer_load_dwordx4 v4, s[8:11], s54 offen sc1 lds
    buffer_load_dwordx4 v4, s[8:11], s54 offen offset:1024 sc1 lds
    s_add_u32 s54, s54, 16384
    s_branch phase2
k1s_h:
    buffer_load_dword v30, v31, s[80:83], 0 offen sc1
    s_branch k1s_r
k1_ffn:
    s_lshl_b32 s48, s4, 8
    s_lshl_b32 s49, s3, 5
    s_add_u32 s48, s48, s49
    v_add_u32 v12, s48, v8
    v_lshl_add_u32 v12, v12, 11, v7
    v_add_u32 v13, 16384, v12
    v_add_u32 v14, 32768, v12
    v_add_u32 v15, 49152, v12
    v_lshrrev_b32 v16, 2, v1
    s_movk_i32 s49, 7168
    v_mul_lo_u32 v16, v16, s49
    v_lshrrev_b32 v17, 5, v1
    v_lshlrev_b32 v17, 1, v17
    v_xor_b32 v17, v17, v10
    v_lshl_add_u32 v16, v17, 4, v16
    s_mul_i32 s48, s5, 448
    s_lshl_b32 s49, s3, 6
    s_add_u32 s48, s48, s49
    v_add_u32 v16, s48, v16
    v_add_u32 v17, 114688, v16
    v_add_u32 v18, 229376, v16
    v_add_u32 v19, 344064, v16
    s_lshl_b32 s52, s3, 12
    s_add_u32 s53, s52, 98304
    s_mov_b32 s61, 28672
    s_movk_i32 s62, 1024
    s_cmp_eq_u32 s3, 7
    s_cselect_b32 s53, 155648, s53
    s_cselect_b32 s61, 0, s61
    s_cselect_b32 s62, 0, s62
    s_cselect_b32 s14, 0, s14
    s_mov_b32 s63, 14
    s_mov_b32 s54, 0
    s_mov_b32 s55, 0
    s_add_u32 s50, s52, 0
    s_add_u32 m0, s50, 0
    s_nop 0
    buffer_load_dwordx4 v12, s[8:11], s54 offen lds
    s_add_u32 m0, s50, 1024
    s_nop 0
    buffer_load_dwordx4 v13, s[8:11], s54 offen lds
    s_add_u32 m0, s50, 2048
    s_nop 0
    buffer_load_dwordx4 v14, s[8:11], s54 offen lds
    s_add_u32 m0, s50, 3072
    s_nop 0
    buffer_load_dwordx4 v15, s[8:11], s54 offen lds
    s_add_u32 s54, s54, 128
    s_mov_b32 s51, s53
    s_mov_b32 m0, s51
    s_nop 0
    buffer_load_dwordx4 v16, s[12:15], s55 offen lds
    s_add_u32 m0, m0, s62
    s_nop 0
    buffer_load_dwordx4 v17, s[12:15], s55 offen lds
    s_add_u32 m0, m0, s62
    s_nop 0
    buffer_load_dwordx4 v18, s[12:15], s55 offen lds
    s_add_u32 m0, m0, s62
    s_nop 0
    buffer_load_dwordx4 v19, s[12:15], s55 offen lds
    s_add_u32 s55, s55, 458752
    s_add_u32 s50, s52, 32768
    s_add_u32 m0, s50, 0
    s_nop 0
    buffer_load_dwordx4 v12, s[8:11], s54 offen lds
    s_add_u32 m0, s50, 1024
    s_nop 0
    buffer_load_dwordx4 v13, s[8:11], s54 offen lds
    s_add_u32 m0, s50, 2048
    s_nop 0
    buffer_load_dwordx4 v14, s[8:11], s54 offen lds
    s_add_u32 m0, s50, 3072
    s_nop 0
    buffer_load_dwordx4 v15, s[8:11], s54 offen lds
    s_add_u32 s54, s54, 128
    s_add_u32 s51, s53, s61
    s_mov_b32 m0, s51
    s_nop 0
    buffer_load_dwordx4 v16, s[12:15], s55 offen lds
    s_add_u32 m0, m0, s62
    s_nop 0
    buffer_load_dwordx4 v17, s[12:15], s55 offen lds
    s_add_u32 m0, m0, s62
    s_nop 0
    buffer_load_dwordx4 v18, s[12:15], s55 offen lds
    s_add_u32 m0, m0, s62
    s_nop 0
    buffer_load_dwordx4 v19, s[12:15], s55 offen lds
    s_add_u32 s55, s55, 458752
    v_lshl_add_u32 v23, v3, 3, v9
    v_lshlrev_b32 v23, 6, v23
    v_lshl_add_u32 v23, v10, 3, v23
    v_and_b32 v24, 1, v3
    v_lshl_add_u32 v20, v24, 5, v23
    v_xor_b32 v21, 32, v20
    s_lshl_b32 s48, s7, 5
    v_xor_b32 v22, s48, v20
    v_add_u32 v22, 110592, v22
    s_lshl_b32 s48, s7, 14
    s_add_u32 s48, s48, 98304
    v_add_u32 v20, s48, v20
    v_add_u32 v21, s48, v21
    v_mov_b64 v[32:33], 0
    v_mov_b64 v[34:35], 0
    v_mov_b64 v[36:37], 0
    v_mov_b64 v[38:39], 0
    v_mov_b64 v[40:41], 0
    v_mov_b64 v[42:43], 0
    v_mov_b64 v[44:45], 0
    v_mov_b64 v[46:47], 0
    v_mov_b64 v[48:49], 0
    v_mov_b64 v[50:51], 0
    v_mov_b64 v[52:53], 0
    v_mov_b64 v[54:55], 0
    v_mov_b64 v[56:57], 0
    v_mov_b64 v[58:59], 0
    v_mov_b64 v[60:61], 0
    v_mov_b64 v[62:63], 0
    v_mov_b64 v[64:65], 0
    v_mov_b64 v[66:67], 0
    v_mov_b64 v[68:69], 0
    v_mov_b64 v[70:71], 0
    v_mov_b64 v[72:73], 0
    v_mov_b64 v[74:75], 0
    v_mov_b64 v[76:77], 0
    v_mov_b64 v[78:79], 0
    v_mov_b64 v[80:81], 0
    v_mov_b64 v[82:83], 0
    v_mov_b64 v[84:85], 0
    v_mov_b64 v[86:87], 0
    v_mov_b64 v[88:89], 0
    v_mov_b64 v[90:91], 0
    v_mov_b64 v[92:93], 0
    v_mov_b64 v[94:95], 0
    v_mov_b64 v[96:97], 0
    v_mov_b64 v[98:99], 0
    v_mov_b64 v[100:101], 0
    v_mov_b64 v[102:103], 0
    v_mov_b64 v[104:105], 0
    v_mov_b64 v[106:107], 0
    v_mov_b64 v[108:109], 0
    v_mov_b64 v[110:111], 0
    v_mov_b64 v[112:113], 0
    v_mov_b64 v[114:115], 0
    v_mov_b64 v[116:117], 0
    v_mov_b64 v[118:119], 0
    v_mov_b64 v[120:121], 0
    v_mov_b64 v[122:123], 0
    v_mov_b64 v[124:125], 0
    v_mov_b64 v[126:127], 0
    v_mov_b64 v[128:129], 0
    v_mov_b64 v[130:131], 0
    v_mov_b64 v[132:133], 0
    v_mov_b64 v[134:135], 0
    v_mov_b64 v[136:137], 0
    v_mov_b64 v[138:139], 0
    v_mov_b64 v[140:141], 0
    v_mov_b64 v[142:143], 0
    s_waitcnt vmcnt(8)
    s_barrier
    ds_read_b64_tr_b16 v[160:161], v20 offset:0
    ds_read_b64_tr_b16 v[162:163], v20 offset:256
    ds_read_b128 v[144:147], v4 offset:0
    ds_read_b128 v[148:151], v4 offset:2048
    ds_read_b128 v[152:155], v4 offset:4096
    ds_read_b128 v[156:159], v4 offset:6144
    ds_read_b64_tr_b16 v[164:165], v21 offset:0
    ds_read_b64_tr_b16 v[166:167], v21 offset:256
    ds_read_b64_tr_b16 v[168:169], v20 offset:4096
    ds_read_b64_tr_b16 v[170:171], v20 offset:4352
    ds_read_b64_tr_b16 v[172:173], v21 offset:4096
    ds_read_b64_tr_b16 v[174:175], v21 offset:4352
    ds_read_b64_tr_b16 v[176:177], v20 offset:8192
    ds_read_b64_tr_b16 v[178:179], v20 offset:8448
    ds_read_b64_tr_b16 v[180:181], v21 offset:8192
    ds_read_b64_tr_b16 v[182:183], v21 offset:8448
    ds_read_b64_tr_b16 v[184:185], v22 offset:0
    ds_read_b64_tr_b16 v[186:187], v22 offset:256
    s_mov_b32 s56, 0
    s_add_u32 s50, s52, 65536
    s_mov_b32 s51, s53
    s_mov_b32 s57, 32768
    s_mov_b32 s58, 28672
    s_mov_b32 s59, 0
    s_mov_b32 s60, 32768
    s_bfe_u32 s69, s2, 0x30003
    s_add_u32 s69, s69, 2
    s_lshl_b32 s68, 1, s69
    s_or_b32 s68, s68, 0x1000
    s_cmp_ge_u32 s3, 4
    s_cselect_b32 s69, 100, s69
k1f_loop:
    s_bitcmp1_b32 s68, s56
    s_cbranch_scc1 k1f_h
k1f_r:
    s_waitcnt lgkmcnt(0)
    v_mfma_f32_16x16x32_bf16 v[32:35], v[160:163], v[144:147], v[32:35]
    ds_read_b64_tr_b16 v[204:205], v20 offset:2048
    v_mfma_f32_16x16x32_bf16 v[36:39], v[160:163], v[148:151], v[36:39]
    ds_read_b64_tr_b16 v[206:207], v20 offset:2304
    v_add_u32 v4, s57, v4
    v_mfma_f32_16x16x32_bf16 v[40:43], v[160:163], v[152:155], v[40:43]
    ds_read_b128 v[188:191], v5 offset:0
    v_mfma_f32_16x16x32_bf16 v[44:47], v[160:163], v[156:159], v[44:47]
    ds_read_b128 v[192:195], v5 offset:2048
    s_add_u32 m0, s50, 0
    v_mfma_f32_16x16x32_bf16 v[48:51], v[164:167], v[144:147], v[48:51]
    ds_read_b128 v[196:199], v5 offset:4096
    buffer_load_dwordx4 v12, s[8:11], s54 offen lds
    v_mfma_f32_16x16x32_bf16 v[52:55], v[164:167], v[148:151], v[52:55]
    ds_read_b128 v[200:203], v5 offset:6144
    v_mfma_f32_16x16x32_bf16 v[56:59], v[164:167], v[152:155], v[56:59]
    v_mfma_f32_16x16x32_bf16 v[60:63], v[164:167], v[156:159], v[60:63]
    ds_read_b64_tr_b16 v[208:209], v21 offset:2048
    v_mfma_f32_16x16x32_bf16 v[64:67], v[168:171], v[144:147], v[64:67]
    ds_read_b64_tr_b16 v[210:211], v21 offset:2304
    v_mfma_f32_16x16x32_bf16 v[68:71], v[168:171], v[148:151], v[68:71]
    ds_read_b64_tr_b16 v[212:213], v20 offset:6144
    s_add_u32 m0, s50, 1024
    v_mfma_f32_16x16x32_bf16 v[72:75], v[168:171], v[152:155], v[72:75]
    ds_read_b64_tr_b16 v[214:215], v20 offset:6400
    buffer_load_dwordx4 v13, s[8:11], s54 offen lds
    v_mfma_f32_16x16x32_bf16 v[76:79], v[168:171], v[156:159], v[76:79]
    ds_read_b64_tr_b16 v[216:217], v21 offset:6144
    v_mfma_f32_16x16x32_bf16 v[80:83], v[172:175], v[144:147], v[80:83]
    ds_read_b64_tr_b16 v[218:219], v21 offset:6400
    v_mfma_f32_16x16x32_bf16 v[84:87], v[172:175], v[148:151], v[84:87]
    v_mfma_f32_16x16x32_bf16 v[88:91], v[172:175], v[152:155], v[88:91]
    ds_read_b64_tr_b16 v[220:221], v20 offset:10240
    v_mfma_f32_16x16x32_bf16 v[92:95], v[172:175], v[156:159], v[92:95]
    ds_read_b64_tr_b16 v[222:223], v20 offset:10496
    s_add_u32 m0, s50, 2048
    v_mfma_f32_16x16x32_bf16 v[96:99], v[176:179], v[144:147], v[96:99]
    ds_read_b64_tr_b16 v[224:225], v21 offset:10240
    buffer_load_dwordx4 v14, s[8:11], s54 offen lds
    v_mfma_f32_16x16x32_bf16 v[100:103], v[176:179], v[148:151], v[100:103]
    ds_read_b64_tr_b16 v[226:227], v21 offset:10496
    v_mfma_f32_16x16x32_bf16 v[104:107], v[176:179], v[152:155], v[104:107]
    ds_read_b64_tr_b16 v[228:229], v22 offset:2048
    v_mfma_f32_16x16x32_bf16 v[108:111], v[176:179], v[156:159], v[108:111]
    ds_read_b64_tr_b16 v[230:231], v22 offset:2304
    v_mfma_f32_16x16x32_bf16 v[112:115], v[180:183], v[144:147], v[112:115]
    v_mfma_f32_16x16x32_bf16 v[116:119], v[180:183], v[148:151], v[116:119]
    s_add_u32 m0, s50, 3072
    v_mfma_f32_16x16x32_bf16 v[120:123], v[180:183], v[152:155], v[120:123]
    buffer_load_dwordx4 v15, s[8:11], s54 offen lds
    v_mfma_f32_16x16x32_bf16 v[124:127], v[180:183], v[156:159], v[124:127]
    v_mfma_f32_16x16x32_bf16 v[128:131], v[184:187], v[144:147], v[128:131]
    v_add_u32 v20, s58, v20
    v_add_u32 v21, s58, v21
    v_add_u32 v22, s58, v22
    v_mfma_f32_16x16x32_bf16 v[132:135], v[184:187], v[148:151], v[132:135]
    s_add_u32 s54, s54, 128
    s_lshl_b32 s50, s59, 15
    s_add_u32 s50, s50, s52
    v_mfma_f32_16x16x32_bf16 v[136:139], v[184:187], v[152:155], v[136:139]
    s_cmp_eq_u32 s3, 7
    v_mfma_f32_16x16x32_bf16 v[140:143], v[184:187], v[156:159], v[140:143]
    s_waitcnt vmcnt(8) lgkmcnt(0)
    s_cbranch_scc1 k1f_w7
    s_waitcnt vmcnt(4)
k1f_w7:
    s_barrier
    v_mfma_f32_16x16x32_bf16 v[32:35], v[204:207], v[188:191], v[32:35]
    ds_read_b64_tr_b16 v[160:161], v20 offset:0
    s_mov_b32 m0, s51
    v_mfma_f32_16x16x32_bf16 v[36:39], v[204:207], v[192:195], v[36:39]
    ds_read_b64_tr_b16 v[162:163], v20 offset:256
    buffer_load_dwordx4 v16, s[12:15], s55 offen lds
    s_add_u32 m0, m0, s62
    v_mfma_f32_16x16x32_bf16 v[40:43], v[204:207], v[196:199], v[40:43]
    ds_read_b128 v[144:147], v4 offset:0
    buffer_load_dwordx4 v17, s[12:15], s55 offen lds
    s_add_u32 m0, m0, s62
    v_mfma_f32_16x16x32_bf16 v[44:47], v[204:207], v[200:203], v[44:47]
    ds_read_b128 v[148:151], v4 offset:2048
    buffer_load_dwordx4 v18, s[12:15], s55 offen lds
    s_add_u32 m0, m0, s62
    v_mfma_f32_16x16x32_bf16 v[48:51], v[208:211], v[188:191], v[48:51]
    ds_read_b128 v[152:155], v4 offset:4096
    buffer_load_dwordx4 v19, s[12:15], s55 offen lds
    v_mfma_f32_16x16x32_bf16 v[52:55], v[208:211], v[192:195], v[52:55]
    ds_read_b128 v[156:159], v4 offset:6144
    v_mfma_f32_16x16x32_bf16 v[56:59], v[208:211], v[196:199], v[56:59]
    ds_read_b64_tr_b16 v[164:165], v21 offset:0
    v_mfma_f32_16x16x32_bf16 v[60:63], v[208:211], v[200:203], v[60:63]
    ds_read_b64_tr_b16 v[166:167], v21 offset:256
    v_mfma_f32_16x16x32_bf16 v[64:67], v[212:215], v[188:191], v[64:67]
    ds_read_b64_tr_b16 v[168:169], v20 offset:4096
    v_mfma_f32_16x16x32_bf16 v[68:71], v[212:215], v[192:195], v[68:71]
    v_mfma_f32_16x16x32_bf16 v[72:75], v[212:215], v[196:199], v[72:75]
    ds_read_b64_tr_b16 v[170:171], v20 offset:4352
    v_mfma_f32_16x16x32_bf16 v[76:79], v[212:215], v[200:203], v[76:79]
    ds_read_b64_tr_b16 v[172:173], v21 offset:4096
    v_mfma_f32_16x16x32_bf16 v[80:83], v[216:219], v[188:191], v[80:83]
    ds_read_b64_tr_b16 v[174:175], v21 offset:4352
    v_mfma_f32_16x16x32_bf16 v[84:87], v[216:219], v[192:195], v[84:87]
    ds_read_b64_tr_b16 v[176:177], v20 offset:8192
    v_mfma_f32_16x16x32_bf16 v[88:91], v[216:219], v[196:199], v[88:91]
    ds_read_b64_tr_b16 v[178:179], v20 offset:8448
    v_mfma_f32_16x16x32_bf16 v[92:95], v[216:219], v[200:203], v[92:95]
    ds_read_b64_tr_b16 v[180:181], v21 offset:8192
    v_mfma_f32_16x16x32_bf16 v[96:99], v[220:223], v[188:191], v[96:99]
    ds_read_b64_tr_b16 v[182:183], v21 offset:8448
    v_mfma_f32_16x16x32_bf16 v[100:103], v[220:223], v[192:195], v[100:103]
    ds_read_b64_tr_b16 v[184:185], v22 offset:0
    v_mfma_f32_16x16x32_bf16 v[104:107], v[220:223], v[196:199], v[104:107]
    ds_read_b64_tr_b16 v[186:187], v22 offset:256
    v_mfma_f32_16x16x32_bf16 v[108:111], v[220:223], v[200:203], v[108:111]
    v_mfma_f32_16x16x32_bf16 v[112:115], v[224:227], v[188:191], v[112:115]
    v_mfma_f32_16x16x32_bf16 v[116:119], v[224:227], v[192:195], v[116:119]
    v_mfma_f32_16x16x32_bf16 v[120:123], v[224:227], v[196:199], v[120:123]
    v_mfma_f32_16x16x32_bf16 v[124:127], v[224:227], v[200:203], v[124:127]
    v_mfma_f32_16x16x32_bf16 v[128:131], v[228:231], v[188:191], v[128:131]
    v_mfma_f32_16x16x32_bf16 v[132:135], v[228:231], v[192:195], v[132:135]
    v_add_u32 v5, s57, v5
    s_add_u32 s55, s55, 458752
    s_sub_u32 s51, s51, s53
    s_xor_b32 s51, s51, s61
    s_add_u32 s51, s51, s53
    s_sub_u32 s58, 0, s58
    v_mfma_f32_16x16x32_bf16 v[136:139], v[228:231], v[196:199], v[136:139]
    s_add_u32 s59, s59, 1
    s_cmp_eq_u32 s59, 3
    s_cselect_b32 s59, 0, s59
    s_cmp_eq_u32 s59, 2
    s_cselect_b32 s57, 0xffff0000, s60
    v_mfma_f32_16x16x32_bf16 v[140:143], v[228:231], v[200:203], v[140:143]
    s_add_u32 s56, s56, 1
    s_cmp_ge_u32 s56, 14
    s_cselect_b32 s10, 0, s10
    s_cmp_ge_u32 s56, s63
    s_cselect_b32 s14, 0, s14
    s_cmp_lt_u32 s56, 16
    s_cbranch_scc1 k1f_loop
    s_waitcnt vmcnt(0) lgkmcnt(0)
    s_barrier
k1f_ng:
    v_readfirstlane_b32 s85, v30
    s_cmp_lg_u32 s85, 0
    s_cbranch_scc1 k1f_ng2
    buffer_load_dword v30, v31, s[80:83], 0 offen sc1
    s_waitcnt vmcnt(0)
    s_branch k1f_ng
k1f_ng2:
    s_lshl_b32 s48, s4, 12
    s_lshl_b32 s49, s5, 7
    s_add_u32 s48, s48, s49
    s_add_u32 s84, s48, 25427968
    s_lshl_b32 s48, s4, 1
    s_lshr_b32 s49, s6, 1
    s_add_u32 s48, s48, s49
    s_mul_i32 s48, s48, 1441792
    s_and_b32 s49, s6, 1
    s_lshl_b32 s49, s49, 12
    s_add_u32 s48, s48, s49
    s_add_u32 s48, s48, 0x80000
    s_mul_i32 s49, s5, 57344
    s_add_u32 s48, s48, s49
    s_add_u32 s33, s48, 24576
    s_lshl_b32 s49, s7, 15
    s_add_u32 s30, s48, s49
    s_add_u32 s31, s30, 8192
    s_add_u32 s32, s30, 16384
    s_mov_b32 s72, 1
    s_bfe_u32 s73, s2, 0x20001
    s_lshl_b32 s73, s73, 2
    s_bfe_u32 s74, s2, 0x20003
    s_add_u32 s73, s73, s74
    s_and_b32 s74, s2, 1
    s_lshl_b32 s74, s74, 2
    s_bfe_u32 s75, s2, 0x20005
    s_add_u32 s74, s74, s75
    s_lshr_b32 s75, s3, 2
    s_bfe_u32 s76, s3, 0x10001
    s_and_b32 s77, s3, 1
    v_lshrrev_b32 v8, 3, v1
    v_and_b32 v7, 7, v1
    s_mov_b32 s12, s90
    s_and_b32 s13, s91, 0xffff
    s_mov_b32 s14, 0x200000
    s_mov_b32 s15, 0x20000
    s_lshl_b32 s48, s74, 7
    s_lshl_b32 s49, s3, 4
    s_add_u32 s48, s48, s49
    v_xor_b32 v5, v7, v8
    v_lshlrev_b32 v5, 4, v5
    v_add_u32 v6, s48, v8
    v_lshl_add_u32 v5, v6, 11, v5
    v_add_u32 v6, 16384, v5
    s_lshl_b32 s52, s3, 11
    s_add_u32 s60, s52, 16384
    s_add_u32 s61, s60, 1024
    s_mov_b32 s55, 768
    s_movk_i32 s56, 128
    s_mov_b32 s50, 0
    s_add_u32 m0, s50, s60
    s_nop 0
    buffer_load_dwordx4 v5, s[12:15], s55 offen lds
    s_add_u32 m0, s50, s61
    s_nop 0
    buffer_load_dwordx4 v6, s[12:15], s55 offen lds
    s_add_u32 s55, s55, s56
    s_mov_b32 s50, 32768
    s_add_u32 m0, s50, s60
    s_nop 0
    buffer_load_dwordx4 v5, s[12:15], s55 offen lds
    s_add_u32 m0, s50, s61
    s_nop 0
    buffer_load_dwordx4 v6, s[12:15], s55 offen lds
    s_add_u32 s55, s55, s56
    s_mov_b32 s50, 65536
    s_add_u32 m0, s50, s60
    s_nop 0
    buffer_load_dwordx4 v5, s[12:15], s55 offen lds
    s_add_u32 m0, s50, s61
    s_nop 0
    buffer_load_dwordx4 v6, s[12:15], s55 offen lds
    s_add_u32 s55, s55, s56
    s_mov_b32 s50, 98304
    s_add_u32 m0, s50, s60
    s_nop 0
    buffer_load_dwordx4 v5, s[12:15], s55 offen lds
    s_add_u32 m0, s50, s61
    s_nop 0
    buffer_load_dwordx4 v6, s[12:15], s55 offen lds
    s_add_u32 s55, s55, s56
    s_mov_b32 s50, 131072
    s_add_u32 m0, s50, s60
    s_nop 0
    buffer_load_dwordx4 v5, s[12:15], s55 offen lds
    s_add_u32 m0, s50, s61
    s_nop 0
    buffer_load_dwordx4 v6, s[12:15], s55 offen lds
    s_add_u32 s55, s55, s56
    s_mov_b32 s34, 1
    s_mov_b32 s35, 5
    s_mov_b32 s36, 8
    s_mov_b32 s37, 35
    s_mov_b32 s38, 38
    s_mov_b32 s39, 1000
    s_mov_b32 s53, 5
    s_mov_b32 s45, 3407872
    s_mov_b32 s80, 1920
    s_mov_b32 s81, 65408
    s_mov_b32 s82, 11
    s_mov_b32 s83, 15
    s_mul_i32 s54, s73, 1441792
    s_add_u32 s62, s54, 950272
    s_add_u32 s54, s54, 360448
    v_lshlrev_b32 v230, 4, v1
    s_lshl_b32 s48, s7, 11
    v_add_u32 v231, s48, v230
    v_lshlrev_b32 v228, 3, v1
    s_lshl_b32 s48, s3, 11
    v_add_u32 v229, s48, v228
    s_lshl_b32 s48, s6, 12
    s_lshl_b32 s49, s7, 10
    s_add_u32 s48, s48, s49
    v_add_u32 v228, s48, v228
    v_max_f32 v128, 0, v128
    v_max_f32 v129, 0, v129
    v_max_f32 v130, 0, v130
    v_max_f32 v131, 0, v131
    v_cvt_pk_bf16_f32 v144, v128, v129
    v_cvt_pk_bf16_f32 v145, v130, v131
    ds_write_b64 v229, v[144:145] offset:0
    v_max_f32 v132, 0, v132
    v_max_f32 v133, 0, v133
    v_max_f32 v134, 0, v134
    v_max_f32 v135, 0, v135
    v_cvt_pk_bf16_f32 v146, v132, v133
    v_cvt_pk_bf16_f32 v147, v134, v135
    ds_write_b64 v229, v[146:147] offset:512
    v_max_f32 v136, 0, v136
    v_max_f32 v137, 0, v137
    v_max_f32 v138, 0, v138
    v_max_f32 v139, 0, v139
    v_cvt_pk_bf16_f32 v148, v136, v137
    v_cvt_pk_bf16_f32 v149, v138, v139
    ds_write_b64 v229, v[148:149] offset:1024
    v_max_f32 v140, 0, v140
    v_max_f32 v141, 0, v141
    v_max_f32 v142, 0, v142
    v_max_f32 v143, 0, v143
    v_cvt_pk_bf16_f32 v150, v140, v141
    v_cvt_pk_bf16_f32 v151, v142, v143
    ds_write_b64 v229, v[150:151] offset:1536
    v_max_f32 v96, 0, v96
    v_max_f32 v97, 0, v97
    v_max_f32 v98, 0, v98
    v_max_f32 v99, 0, v99
    v_cvt_pk_bf16_f32 v128, v96, v97
    v_cvt_pk_bf16_f32 v129, v98, v99
    v_max_f32 v112, 0, v112
    v_max_f32 v113, 0, v113
    v_max_f32 v114, 0, v114
    v_max_f32 v115, 0, v115
    v_cvt_pk_bf16_f32 v130, v112, v113
    v_cvt_pk_bf16_f32 v131, v114, v115
    buffer_store_dwordx4 v[128:131], v230, s[24:27], s32 offen offset:0 sc1
    v_max_f32 v100, 0, v100
    v_max_f32 v101, 0, v101
    v_max_f32 v102, 0, v102
    v_max_f32 v103, 0, v103
    v_cvt_pk_bf16_f32 v132, v100, v101
    v_cvt_pk_bf16_f32 v133, v102, v103
    v_max_f32 v116, 0, v116
    v_max_f32 v117, 0, v117
    v_max_f32 v118, 0, v118
    v_max_f32 v119, 0, v119
    v_cvt_pk_bf16_f32 v134, v116, v117
    v_cvt_pk_bf16_f32 v135, v118, v119
    buffer_store_dwordx4 v[132:135], v230, s[24:27], s32 offen offset:1024 sc1
    v_max_f32 v104, 0, v104
    v_max_f32 v105, 0, v105
    v_max_f32 v106, 0, v106
    v_max_f32 v107, 0, v107
    v_cvt_pk_bf16_f32 v136, v104, v105
    v_cvt_pk_bf16_f32 v137, v106, v107
    v_max_f32 v120, 0, v120
    v_max_f32 v121, 0, v121
    v_max_f32 v122, 0, v122
    v_max_f32 v123, 0, v123
    v_cvt_pk_bf16_f32 v138, v120, v121
    v_cvt_pk_bf16_f32 v139, v122, v123
    buffer_store_dwordx4 v[136:139], v230, s[24:27], s32 offen offset:2048 sc1
    v_max_f32 v108, 0, v108
    v_max_f32 v109, 0, v109
    v_max_f32 v110, 0, v110
    v_max_f32 v111, 0, v111
    v_cvt_pk_bf16_f32 v140, v108, v109
    v_cvt_pk_bf16_f32 v141, v110, v111
    v_max_f32 v124, 0, v124
    v_max_f32 v125, 0, v125
    v_max_f32 v126, 0, v126
    v_max_f32 v127, 0, v127
    v_cvt_pk_bf16_f32 v142, v124, v125
    v_cvt_pk_bf16_f32 v143, v126, v127
    buffer_store_dwordx4 v[140:143], v230, s[24:27], s32 offen offset:3072 sc1
    s_waitcnt lgkmcnt(0)
    s_barrier
    ds_read_b64 v[144:145], v228 offset:0
    ds_read_b64 v[146:147], v228 offset:2048
    ds_read_b64 v[148:149], v228 offset:512
    ds_read_b64 v[150:151], v228 offset:2560
    v_max_f32 v64, 0, v64
    v_max_f32 v65, 0, v65
    v_max_f32 v66, 0, v66
    v_max_f32 v67, 0, v67
    v_cvt_pk_bf16_f32 v112, v64, v65
    v_cvt_pk_bf16_f32 v113, v66, v67
    v_max_f32 v80, 0, v80
    v_max_f32 v81, 0, v81
    v_max_f32 v82, 0, v82
    v_max_f32 v83, 0, v83
    v_cvt_pk_bf16_f32 v114, v80, v81
    v_cvt_pk_bf16_f32 v115, v82, v83
    buffer_store_dwordx4 v[112:115], v230, s[24:27], s31 offen offset:0 sc1
    v_max_f32 v68, 0, v68
    v_max_f32 v69, 0, v69
    v_max_f32 v70, 0, v70
    v_max_f32 v71, 0, v71
    v_cvt_pk_bf16_f32 v116, v68, v69
    v_cvt_pk_bf16_f32 v117, v70, v71
    v_max_f32 v84, 0, v84
    v_max_f32 v85, 0, v85
    v_max_f32 v86, 0, v86
    v_max_f32 v87, 0, v87
    v_cvt_pk_bf16_f32 v118, v84, v85
    v_cvt_pk_bf16_f32 v119, v86, v87
    buffer_store_dwordx4 v[116:119], v230, s[24:27], s31 offen offset:1024 sc1
    v_max_f32 v72, 0, v72
    v_max_f32 v73, 0, v73
    v_max_f32 v74, 0, v74
    v_max_f32 v75, 0, v75
    v_cvt_pk_bf16_f32 v120, v72, v73
    v_cvt_pk_bf16_f32 v121, v74, v75
    v_max_f32 v88, 0, v88
    v_max_f32 v89, 0, v89
    v_max_f32 v90, 0, v90
    v_max_f32 v91, 0, v91
    v_cvt_pk_bf16_f32 v122, v88, v89
    v_cvt_pk_bf16_f32 v123, v90, v91
    buffer_store_dwordx4 v[120:123], v230, s[24:27], s31 offen offset:2048 sc1
    v_max_f32 v76, 0, v76
    v_max_f32 v77, 0, v77
    v_max_f32 v78, 0, v78
    v_max_f32 v79, 0, v79
    v_cvt_pk_bf16_f32 v124, v76, v77
    v_cvt_pk_bf16_f32 v125, v78, v79
    v_max_f32 v92, 0, v92
    v_max_f32 v93, 0, v93
    v_max_f32 v94, 0, v94
    v_max_f32 v95, 0, v95
    v_cvt_pk_bf16_f32 v126, v92, v93
    v_cvt_pk_bf16_f32 v127, v94, v95
    buffer_store_dwordx4 v[124:127], v230, s[24:27], s31 offen offset:3072 sc1
    v_max_f32 v32, 0, v32
    v_max_f32 v33, 0, v33
    v_max_f32 v34, 0, v34
    v_max_f32 v35, 0, v35
    v_cvt_pk_bf16_f32 v96, v32, v33
    v_cvt_pk_bf16_f32 v97, v34, v35
    v_max_f32 v48, 0, v48
    v_max_f32 v49, 0, v49
    v_max_f32 v50, 0, v50
    v_max_f32 v51, 0, v51
    v_cvt_pk_bf16_f32 v98, v48, v49
    v_cvt_pk_bf16_f32 v99, v50, v51
    buffer_store_dwordx4 v[96:99], v230, s[24:27], s30 offen offset:0 sc1
    v_max_f32 v36, 0, v36
    v_max_f32 v37, 0, v37
    v_max_f32 v38, 0, v38
    v_max_f32 v39, 0, v39
    v_cvt_pk_bf16_f32 v100, v36, v37
    v_cvt_pk_bf16_f32 v101, v38, v39
    v_max_f32 v52, 0, v52
    v_max_f32 v53, 0, v53
    v_max_f32 v54, 0, v54
    v_max_f32 v55, 0, v55
    v_cvt_pk_bf16_f32 v102, v52, v53
    v_cvt_pk_bf16_f32 v103, v54, v55
    buffer_store_dwordx4 v[100:103], v230, s[24:27], s30 offen offset:1024 sc1
    v_max_f32 v40, 0, v40
    v_max_f32 v41, 0, v41
    v_max_f32 v42, 0, v42
    v_max_f32 v43, 0, v43
    v_cvt_pk_bf16_f32 v104, v40, v41
    v_cvt_pk_bf16_f32 v105, v42, v43
    v_max_f32 v56, 0, v56
    v_max_f32 v57, 0, v57
    v_max_f32 v58, 0, v58
    v_max_f32 v59, 0, v59
    v_cvt_pk_bf16_f32 v106, v56, v57
    v_cvt_pk_bf16_f32 v107, v58, v59
    buffer_store_dwordx4 v[104:107], v230, s[24:27], s30 offen offset:2048 sc1
    v_max_f32 v44, 0, v44
    v_max_f32 v45, 0, v45
    v_max_f32 v46, 0, v46
    v_max_f32 v47, 0, v47
    v_cvt_pk_bf16_f32 v108, v44, v45
    v_cvt_pk_bf16_f32 v109, v46, v47
    v_max_f32 v60, 0, v60
    v_max_f32 v61, 0, v61
    v_max_f32 v62, 0, v62
    v_max_f32 v63, 0, v63
    v_cvt_pk_bf16_f32 v110, v60, v61
    v_cvt_pk_bf16_f32 v111, v62, v63
    buffer_store_dwordx4 v[108:111], v230, s[24:27], s30 offen offset:3072 sc1
    s_waitcnt lgkmcnt(0)
    buffer_store_dwordx4 v[144:147], v231, s[24:27], s33 offen offset:0 sc1
    buffer_store_dwordx4 v[148:151], v231, s[24:27], s33 offen offset:1024 sc1
    s_mov_b32 s20, s28
    s_and_b32 s21, s29, 0xffff
    s_mov_b32 s22, 0x400000
    s_mov_b32 s23, 0x20000
    s_mov_b32 s64, s92
    s_and_b32 s65, s93, 0xffff
    s_mov_b32 s66, 0x800
    s_mov_b32 s67, 0x20000
    s_mov_b32 s68, s86
    s_and_b32 s69, s87, 0xffff
    s_mov_b32 s70, 0x800000
    s_mov_b32 s71, 0x20000
    s_mov_b32 s16, s94
    s_and_b32 s17, s95, 0xffff
    s_mov_b32 s18, 0x700000
    s_mov_b32 s19, 0x20000
    v_bfe_u32 v9, v1, 2, 2
    v_and_b32 v10, 3, v1
    s_lshl_b32 s48, s3, 3
    v_add_u32 v11, s48, v8
    v_lshlrev_b32 v11, 11, v11
    v_lshlrev_b32 v12, 1, v3
    v_xor_b32 v12, v12, v7
    v_lshl_add_u32 v11, v12, 4, v11
    s_lshl_b32 s48, s74, 8
    v_add_u32 v11, s48, v11
    v_add_u32 v12, 128, v11
    s_lshl_b32 s63, s3, 10
    s_add_u32 s63, s63, 16384
    s_lshl_b32 s48, s75, 13
    s_lshl_b32 s49, s76, 12
    s_add_u32 s48, s48, s49
    v_lshrrev_b32 v21, 1, v3
    v_lshlrev_b32 v21, 4, v21
    v_lshrrev_b32 v22, 1, v10
    v_lshl_add_u32 v21, v22, 3, v21
    v_and_b32 v23, 1, v3
    v_lshl_add_u32 v21, v23, 2, v21
    v_add_u32 v21, v21, v9
    v_lshlrev_b32 v13, 4, v21
    v_lshl_add_u32 v13, v22, 9, v13
    v_and_b32 v22, 1, v10
    v_lshl_add_u32 v13, v22, 3, v13
    v_add_u32 v13, s48, v13
    v_xor_b32 v14, 128, v13
    v_lshlrev_b32 v16, 4, v1
    v_add_u32 v16, s48, v16
    s_lshl_b32 s48, s75, 2
    v_add_u32 v15, s48, v3
    v_xor_b32 v15, v15, v7
    v_lshlrev_b32 v15, 4, v15
    v_lshl_add_u32 v15, v2, 7, v15
    s_lshl_b32 s48, s77, 13
    s_add_u32 s48, s48, 16384
    v_add_u32 v15, s48, v15
    s_lshl_b32 s49, s75, 12
    s_add_u32 s48, s48, s49
    v_lshl_add_u32 v21, v3, 2, v9
    v_lshlrev_b32 v21, 7, v21
    v_lshl_add_u32 v21, v10, 3, v21
    v_add_u32 v21, s48, v21
    v_lshlrev_b32 v22, 1, v23
    v_lshrrev_b32 v23, 1, v9
    v_add_u32 v22, v22, v23
    v_xor_b32 v23, 0, v22
    v_lshl_add_u32 v17, v23, 5, v21
    v_xor_b32 v23, 1, v22
    v_lshl_add_u32 v18, v23, 5, v21
    v_xor_b32 v23, 2, v22
    v_lshl_add_u32 v19, v23, 5, v21
    v_xor_b32 v23, 3, v22
    v_lshl_add_u32 v20, v23, 5, v21
    v_mov_b64 v[32:33], 0
    v_mov_b64 v[34:35], 0
    v_mov_b64 v[36:37], 0
    v_mov_b64 v[38:39], 0
    v_mov_b64 v[40:41], 0
    v_mov_b64 v[42:43], 0
    v_mov_b64 v[44:45], 0
    v_mov_b64 v[46:47], 0
    v_mov_b64 v[48:49], 0
    v_mov_b64 v[50:51], 0
    v_mov_b64 v[52:53], 0
    v_mov_b64 v[54:55], 0
    v_mov_b64 v[56:57], 0
    v_mov_b64 v[58:59], 0
    v_mov_b64 v[60:61], 0
    v_mov_b64 v[62:63], 0
    v_mov_b64 v[64:65], 0
    v_mov_b64 v[66:67], 0
    v_mov_b64 v[68:69], 0
    v_mov_b64 v[70:71], 0
    v_mov_b64 v[72:73], 0
    v_mov_b64 v[74:75], 0
    v_mov_b64 v[76:77], 0
    v_mov_b64 v[78:79], 0
    v_mov_b64 v[80:81], 0
    v_mov_b64 v[82:83], 0
    v_mov_b64 v[84:85], 0
    v_mov_b64 v[86:87], 0
    v_mov_b64 v[88:89], 0
    v_mov_b64 v[90:91], 0
    v_mov_b64 v[92:93], 0
    v_mov_b64 v[94:95], 0
    s_lshl_b32 s78, s73, 7
    s_lshl_b32 s48, s76, 6
    s_add_u32 s78, s78, s48
    s_lshl_b32 s40, s78, 2
    s_add_u32 s40, s40, 25165824
    s_lshl_b32 s49, s75, 7
    s_add_u32 s41, s40, s49
    s_lshl_b32 s49, s75, 5
    s_add_u32 s78, s78, s49
    s_lshl_b32 s79, s74, 7
    s_lshl_b32 s48, s77, 6
    s_add_u32 s79, s79, s48
    s_lshl_b32 s48, s72, 5
    s_add_u32 s79, s79, s48
    s_lshl_b32 s42, s78, 11
    s_lshl_b32 s44, s79, 1
    s_add_u32 s42, s42, s44
    s_add_u32 s43, s42, 32768
    v_mov_b32 v24, v13
    v_mov_b32 v25, v14
    v_mov_b32 v26, v15
    s_mov_b32 s8, s46
    s_and_b32 s9, s47, 0xffff
    s_mov_b32 s10, 0x10000000
    s_mov_b32 s11, 0x20000
    v_lshlrev_b32 v29, 7, v1
    s_lshr_b32 s48, s73, 1
    s_lshl_b32 s48, s48, 12
    s_add_u32 s57, s48, 25427968
    s_add_u32 s48, s48, 25493504
    v_lshlrev_b32 v4, 4, v1
    v_add_u32 v4, s52, v4
    s_cmp_lg_u32 s3, 0
    s_cbranch_scc1 k2_fbarf
    s_mov_b32 s59, 400000
    s_mov_b64 exec, 0xffff
k2_fpollf:
    buffer_load_dword v30, v29, s[24:27], s48 offen sc1
    s_sub_u32 s59, s59, 1
    s_waitcnt vmcnt(0)
    v_cmp_ne_u32 vcc, s85, v30
    s_cmp_eq_u32 s59, 0
    s_cbranch_scc1 k2_fokf
    s_nop 2
    s_cbranch_vccz k2_fokf
    s_branch k2_fpollf
k2_fokf:
    s_mov_b64 exec, -1
k2_fbarf:
    v_mov_b32 v30, 0
    s_barrier
    s_add_u32 m0, s52, 0
    s_nop 0
    buffer_load_dwordx4 v4, s[8:11], s54 offen sc1 lds
    buffer_load_dwordx4 v4, s[8:11], s54 offen offset:1024 sc1 lds
    s_add_u32 s54, s54, 16384
    s_add_u32 m0, s52, 32768
    s_nop 0
    buffer_load_dwordx4 v4, s[8:11], s54 offen sc1 lds
    buffer_load_dwordx4 v4, s[8:11], s54 offen offset:1024 sc1 lds
    s_add_u32 s54, s54, 16384
    s_add_u32 m0, s52, 65536
    s_nop 0
    buffer_load_dwordx4 v4, s[8:11], s54 offen sc1 lds
    buffer_load_dwordx4 v4, s[8:11], s54 offen offset:1024 sc1 lds
    s_add_u32 s54, s54, 16384
    s_add_u32 m0, s52, 98304
    s_nop 0
    buffer_load_dwordx4 v4, s[8:11], s54 offen sc1 lds
    buffer_load_dwordx4 v4, s[8:11], s54 offen offset:1024 sc1 lds
    s_add_u32 s54, s54, 16384
    s_add_u32 m0, s52, 131072
    s_nop 0
    buffer_load_dwordx4 v4, s[8:11], s54 offen sc1 lds
    buffer_load_dwordx4 v4, s[8:11], s54 offen offset:1024 sc1 lds
    s_add_u32 s54, s54, 16384
    s_branch phase2
k1f_h:
    s_cmp_lg_u32 s56, 12
    s_cbranch_scc1 k1f_np
    buffer_load_dword v30, v31, s[80:83], 0 offen sc1
k1f_np:
    s_cmp_lg_u32 s56, s69
    s_cbranch_scc1 k1f_nw
    s_lshl_b32 s48, s4, 4
    s_add_u32 s48, s48, s5
    s_lshl_b32 s48, s48, 2
    s_and_b32 s49, s3, 3
    s_add_u32 s48, s48, s49
    s_and_b32 s49, s48, 255
    s_lshl_b32 s49, s49, 13
    s_cmp_ge_u32 s48, 256
    s_cselect_b32 s64, s90, s88
    s_cselect_b32 s65, s91, s89
    s_mov_b32 s66, 0x200000
    s_mov_b32 s67, 0x20000
    s_lshl_b32 s48, s48, 14
    s_cmp_ge_u32 s3, 4
    s_cselect_b32 s64, s94, s64
    s_cselect_b32 s65, s95, s65
    s_cselect_b32 s66, 0x700000, s66
    s_cselect_b32 s49, s48, s49
    s_cselect_b32 s48, 8192, 0
    s_and_b32 s65, s65, 0xffff
    v_lshlrev_b32 v250, 7, v1
    v_add_u32 v250, s49, v250
    v_add_u32 v249, s48, v250
    buffer_load_dword v251, v250, s[64:67], 0 offen
    buffer_load_dword v251, v250, s[64:67], 0 offen offset:64
k1f_nw:
    s_branch k1f_r
phase2:
    s_waitcnt vmcnt(0)
    s_barrier
    s_cmp_eq_u32 s72, 1
    s_mov_b32 s30, 0x8822800
    s_cselect_b32 s30, 0x8822, s30
    s_mov_b32 s31, 0
    s_add_u32 s48, s3, 1
    s_cmp_lg_u32 s48, s72
    s_cbranch_scc1 k2_nf
    v_mov_b32 v21, s85
    s_mov_b64 exec, 1
    buffer_store_dword v21, v31, s[24:27], s84 offen sc1
    s_mov_b64 exec, -1
k2_nf:
    ds_read_b128 v[176:179], v26 offset:0
    ds_read_b64_tr_b16 v[160:161], v24 offset:0
    ds_read_b64_tr_b16 v[162:163], v25 offset:0
    ds_read_b64_tr_b16 v[164:165], v24 offset:1024
    ds_read_b64_tr_b16 v[166:167], v25 offset:1024
    ds_read_b64_tr_b16 v[168:169], v24 offset:2048
    ds_read_b64_tr_b16 v[170:171], v25 offset:2048
    ds_read_b64_tr_b16 v[172:173], v24 offset:3072
    ds_read_b64_tr_b16 v[174:175], v25 offset:3072
    ds_read_b128 v[180:183], v26 offset:2048
    ds_read_b128 v[184:187], v26 offset:4096
    ds_read_b128 v[188:191], v26 offset:6144
    s_mov_b32 s51, 32768
    s_mov_b32 s50, 0
    s_mov_b32 s58, 0
    v_add_u32 v24, s51, v13
    v_add_u32 v25, s51, v14
    v_add_u32 v26, s51, v15
    .p2align 4
k2_sloop:
    s_waitcnt vmcnt(12) lgkmcnt(0)
    s_barrier
    v_mfma_f32_16x16x32_bf16 v[32:35], v[176:179], v[160:163], v[32:35]
    ds_read_b128 v[208:211], v26 offset:0
    ds_read_b64_tr_b16 v[192:193], v24 offset:0
    s_add_u32 m0, s50, s52
    v_mfma_f32_16x16x32_bf16 v[36:39], v[176:179], v[164:167], v[36:39]
    ds_read_b64_tr_b16 v[194:195], v25 offset:0
    buffer_load_dwordx4 v4, s[8:11], s54 offen sc1 lds
    v_mfma_f32_16x16x32_bf16 v[40:43], v[176:179], v[168:171], v[40:43]
    ds_read_b64_tr_b16 v[196:197], v24 offset:1024
    v_mfma_f32_16x16x32_bf16 v[44:47], v[176:179], v[172:175], v[44:47]
    ds_read_b64_tr_b16 v[198:199], v25 offset:1024
    v_mfma_f32_16x16x32_bf16 v[48:51], v[180:183], v[160:163], v[48:51]
    ds_read_b64_tr_b16 v[200:201], v24 offset:2048
    buffer_load_dwordx4 v4, s[8:11], s54 offen offset:1024 sc1 lds
    v_mfma_f32_16x16x32_bf16 v[52:55], v[180:183], v[164:167], v[52:55]
    ds_read_b64_tr_b16 v[202:203], v25 offset:2048
    v_mfma_f32_16x16x32_bf16 v[56:59], v[180:183], v[168:171], v[56:59]
    ds_read_b64_tr_b16 v[204:205], v24 offset:3072
    s_add_u32 m0, s50, s60
    v_mfma_f32_16x16x32_bf16 v[60:63], v[180:183], v[172:175], v[60:63]
    ds_read_b64_tr_b16 v[206:207], v25 offset:3072
    buffer_load_dwordx4 v5, s[12:15], s55 offen lds
    v_mfma_f32_16x16x32_bf16 v[64:67], v[184:187], v[160:163], v[64:67]
    ds_read_b128 v[212:215], v26 offset:2048
    v_mfma_f32_16x16x32_bf16 v[68:71], v[184:187], v[164:167], v[68:71]
    ds_read_b128 v[216:219], v26 offset:4096
    s_add_u32 m0, s50, s61
    v_mfma_f32_16x16x32_bf16 v[72:75], v[184:187], v[168:171], v[72:75]
    ds_read_b128 v[220:223], v26 offset:6144
    buffer_load_dwordx4 v6, s[12:15], s55 offen lds
    v_mfma_f32_16x16x32_bf16 v[76:79], v[184:187], v[172:175], v[76:79]
    s_mov_b32 s50, s51
    s_add_u32 s51, s51, 32768
    s_cmp_eq_u32 s51, 0x28000
    s_cselect_b32 s51, 0, s51
    v_mfma_f32_16x16x32_bf16 v[80:83], v[188:191], v[160:163], v[80:83]
    v_add_u32 v24, s51, v13
    v_add_u32 v25, s51, v14
    v_add_u32 v26, s51, v15
    s_add_u32 s58, s58, 1
    v_mfma_f32_16x16x32_bf16 v[84:87], v[188:191], v[164:167], v[84:87]
    s_add_u32 s54, s54, 16384
    s_add_u32 s55, s55, s56
    v_mfma_f32_16x16x32_bf16 v[88:91], v[188:191], v[168:171], v[88:91]
    s_bitcmp1_b64 s[30:31], s58
    v_mfma_f32_16x16x32_bf16 v[92:95], v[188:191], v[172:175], v[92:95]
    s_cbranch_scc1 k2_hsw
k2_rsw:
    s_waitcnt vmcnt(12) lgkmcnt(0)
    s_barrier
    v_mfma_f32_16x16x32_bf16 v[32:35], v[208:211], v[192:195], v[32:35]
    ds_read_b128 v[176:179], v26 offset:0
    ds_read_b64_tr_b16 v[160:161], v24 offset:0
    s_add_u32 m0, s50, s52
    v_mfma_f32_16x16x32_bf16 v[36:39], v[208:211], v[196:199], v[36:39]
    ds_read_b64_tr_b16 v[162:163], v25 offset:0
    buffer_load_dwordx4 v4, s[8:11], s54 offen sc1 lds
    v_mfma_f32_16x16x32_bf16 v[40:43], v[208:211], v[200:203], v[40:43]
    ds_read_b64_tr_b16 v[164:165], v24 offset:1024
    v_mfma_f32_16x16x32_bf16 v[44:47], v[208:211], v[204:207], v[44:47]
    ds_read_b64_tr_b16 v[166:167], v25 offset:1024
    v_mfma_f32_16x16x32_bf16 v[48:51], v[212:215], v[192:195], v[48:51]
    ds_read_b64_tr_b16 v[168:169], v24 offset:2048
    buffer_load_dwordx4 v4, s[8:11], s54 offen offset:1024 sc1 lds
    v_mfma_f32_16x16x32_bf16 v[52:55], v[212:215], v[196:199], v[52:55]
    ds_read_b64_tr_b16 v[170:171], v25 offset:2048
    v_mfma_f32_16x16x32_bf16 v[56:59], v[212:215], v[200:203], v[56:59]
    ds_read_b64_tr_b16 v[172:173], v24 offset:3072
    s_add_u32 m0, s50, s60
    v_mfma_f32_16x16x32_bf16 v[60:63], v[212:215], v[204:207], v[60:63]
    ds_read_b64_tr_b16 v[174:175], v25 offset:3072
    buffer_load_dwordx4 v5, s[12:15], s55 offen lds
    v_mfma_f32_16x16x32_bf16 v[64:67], v[216:219], v[192:195], v[64:67]
    ds_read_b128 v[180:183], v26 offset:2048
    v_mfma_f32_16x16x32_bf16 v[68:71], v[216:219], v[196:199], v[68:71]
    ds_read_b128 v[184:187], v26 offset:4096
    s_add_u32 m0, s50, s61
    v_mfma_f32_16x16x32_bf16 v[72:75], v[216:219], v[200:203], v[72:75]
    ds_read_b128 v[188:191], v26 offset:6144
    buffer_load_dwordx4 v6, s[12:15], s55 offen lds
    v_mfma_f32_16x16x32_bf16 v[76:79], v[216:219], v[204:207], v[76:79]
    s_mov_b32 s50, s51
    s_add_u32 s51, s51, 32768
    s_cmp_eq_u32 s51, 0x28000
    s_cselect_b32 s51, 0, s51
    v_mfma_f32_16x16x32_bf16 v[80:83], v[220:223], v[192:195], v[80:83]
    v_add_u32 v24, s51, v13
    v_add_u32 v25, s51, v14
    v_add_u32 v26, s51, v15
    s_add_u32 s58, s58, 1
    v_mfma_f32_16x16x32_bf16 v[84:87], v[220:223], v[196:199], v[84:87]
    s_add_u32 s54, s54, 16384
    s_add_u32 s55, s55, s56
    v_mfma_f32_16x16x32_bf16 v[88:91], v[220:223], v[200:203], v[88:91]
    s_cmp_lt_u32 s58, s36
    v_mfma_f32_16x16x32_bf16 v[92:95], v[220:223], v[204:207], v[92:95]
    s_cbranch_scc1 k2_sloop
    s_waitcnt vmcnt(12) lgkmcnt(0)
    s_barrier
    v_mfma_f32_16x16x32_bf16 v[32:35], v[176:179], v[160:163], v[32:35]
    ds_read_b128 v[208:211], v26 offset:0
    ds_read_b64_tr_b16 v[192:193], v24 offset:0
    s_add_u32 m0, s50, s52
    v_mov_b64 v[96:97], 0
    v_mfma_f32_16x16x32_bf16 v[36:39], v[176:179], v[164:167], v[36:39]
    ds_read_b64_tr_b16 v[194:195], v25 offset:0
    buffer_load_dwordx4 v4, s[8:11], s54 offen sc1 lds
    v_mov_b64 v[98:99], 0
    v_mfma_f32_16x16x32_bf16 v[40:43], v[176:179], v[168:171], v[40:43]
    ds_read_b64_tr_b16 v[196:197], v24 offset:1024
    v_mov_b64 v[100:101], 0
    v_mfma_f32_16x16x32_bf16 v[44:47], v[176:179], v[172:175], v[44:47]
    ds_read_b64_tr_b16 v[198:199], v25 offset:1024
    v_mov_b64 v[102:103], 0
    v_mfma_f32_16x16x32_bf16 v[48:51], v[180:183], v[160:163], v[48:51]
    ds_read_b64_tr_b16 v[200:201], v24 offset:2048
    buffer_load_dwordx4 v4, s[8:11], s54 offen offset:1024 sc1 lds
    v_mov_b64 v[104:105], 0
    v_mfma_f32_16x16x32_bf16 v[52:55], v[180:183], v[164:167], v[52:55]
    ds_read_b64_tr_b16 v[202:203], v25 offset:2048
    v_mov_b64 v[106:107], 0
    v_mfma_f32_16x16x32_bf16 v[56:59], v[180:183], v[168:171], v[56:59]
    ds_read_b64_tr_b16 v[204:205], v24 offset:3072
    s_add_u32 m0, s50, s60
    v_mov_b64 v[108:109], 0
    v_mfma_f32_16x16x32_bf16 v[60:63], v[180:183], v[172:175], v[60:63]
    ds_read_b64_tr_b16 v[206:207], v25 offset:3072
    buffer_load_dwordx4 v5, s[12:15], s55 offen lds
    v_mov_b64 v[110:111], 0
    v_mfma_f32_16x16x32_bf16 v[64:67], v[184:187], v[160:163], v[64:67]
    ds_read_b128 v[212:215], v26 offset:2048
    v_mov_b64 v[112:113], 0
    v_mfma_f32_16x16x32_bf16 v[68:71], v[184:187], v[164:167], v[68:71]
    ds_read_b128 v[216:219], v26 offset:4096
    s_add_u32 m0, s50, s61
    v_mov_b64 v[114:115], 0
    v_mfma_f32_16x16x32_bf16 v[72:75], v[184:187], v[168:171], v[72:75]
    ds_read_b128 v[220:223], v26 offset:6144
    buffer_load_dwordx4 v6, s[12:15], s55 offen lds
    v_mov_b64 v[116:117], 0
    v_mfma_f32_16x16x32_bf16 v[76:79], v[184:187], v[172:175], v[76:79]
    s_mov_b32 s50, s51
    s_add_u32 s51, s51, 32768
    s_cmp_eq_u32 s51, 0x28000
    s_cselect_b32 s51, 0, s51
    v_mov_b64 v[118:119], 0
    v_mfma_f32_16x16x32_bf16 v[80:83], v[188:191], v[160:163], v[80:83]
    v_add_u32 v24, s51, v16
    v_add_u32 v25, s51, v17
    v_add_u32 v26, s51, v18
    v_add_u32 v27, s51, v19
    v_add_u32 v28, s51, v20
    s_add_u32 s58, s58, 1
    v_mov_b64 v[120:121], 0
    v_mfma_f32_16x16x32_bf16 v[84:87], v[188:191], v[164:167], v[84:87]
    s_add_u32 s54, s54, 16384
    s_add_u32 s55, s55, s56
    v_mov_b64 v[122:123], 0
    v_mfma_f32_16x16x32_bf16 v[88:91], v[188:191], v[168:171], v[88:91]
    v_mov_b64 v[124:125], 0
    v_mfma_f32_16x16x32_bf16 v[92:95], v[188:191], v[172:175], v[92:95]
    v_mov_b64 v[126:127], 0
    s_waitcnt vmcnt(12) lgkmcnt(0)
    s_barrier
    v_mfma_f32_16x16x32_bf16 v[32:35], v[208:211], v[192:195], v[32:35]
    ds_read_b64_tr_b16 v[176:177], v25 offset:0
    ds_read_b64_tr_b16 v[178:179], v25 offset:2048
    s_add_u32 m0, s50, s52
    v_mov_b64 v[128:129], 0
    v_mfma_f32_16x16x32_bf16 v[36:39], v[208:211], v[196:199], v[36:39]
    ds_read_b128 v[160:163], v24 offset:0
    buffer_load_dwordx4 v4, s[8:11], s54 offen sc1 lds
    v_mov_b64 v[130:131], 0
    v_mfma_f32_16x16x32_bf16 v[40:43], v[208:211], v[200:203], v[40:43]
    ds_read_b128 v[164:167], v24 offset:1024
    v_mov_b64 v[132:133], 0
    v_mfma_f32_16x16x32_bf16 v[44:47], v[208:211], v[204:207], v[44:47]
    ds_read_b128 v[168:171], v24 offset:2048
    v_mov_b64 v[134:135], 0
    v_mfma_f32_16x16x32_bf16 v[48:51], v[212:215], v[192:195], v[48:51]
    ds_read_b128 v[172:175], v24 offset:3072
    buffer_load_dwordx4 v4, s[8:11], s54 offen offset:1024 sc1 lds
    v_mov_b64 v[136:137], 0
    v_mfma_f32_16x16x32_bf16 v[52:55], v[212:215], v[196:199], v[52:55]
    ds_read_b64_tr_b16 v[180:181], v26 offset:0
    v_mov_b64 v[138:139], 0
    v_mfma_f32_16x16x32_bf16 v[56:59], v[212:215], v[200:203], v[56:59]
    ds_read_b64_tr_b16 v[182:183], v26 offset:2048
    s_add_u32 m0, s50, s60
    v_mov_b64 v[140:141], 0
    v_mfma_f32_16x16x32_bf16 v[60:63], v[212:215], v[204:207], v[60:63]
    ds_read_b64_tr_b16 v[184:185], v27 offset:0
    buffer_load_dwordx4 v5, s[12:15], s55 offen lds
    v_mov_b64 v[142:143], 0
    v_mfma_f32_16x16x32_bf16 v[64:67], v[216:219], v[192:195], v[64:67]
    ds_read_b64_tr_b16 v[186:187], v27 offset:2048
    v_mov_b64 v[144:145], 0
    v_mfma_f32_16x16x32_bf16 v[68:71], v[216:219], v[196:199], v[68:71]
    ds_read_b64_tr_b16 v[188:189], v28 offset:0
    s_add_u32 m0, s50, s61
    v_mov_b64 v[146:147], 0
    v_mfma_f32_16x16x32_bf16 v[72:75], v[216:219], v[200:203], v[72:75]
    ds_read_b64_tr_b16 v[190:191], v28 offset:2048
    buffer_load_dwordx4 v6, s[12:15], s55 offen lds
    v_mov_b64 v[148:149], 0
    v_mfma_f32_16x16x32_bf16 v[76:79], v[216:219], v[204:207], v[76:79]
    s_mov_b32 s50, s51
    s_add_u32 s51, s51, 32768
    s_cmp_eq_u32 s51, 0x28000
    s_cselect_b32 s51, 0, s51
    v_mov_b64 v[150:151], 0
    v_mfma_f32_16x16x32_bf16 v[80:83], v[220:223], v[192:195], v[80:83]
    v_add_u32 v24, s51, v16
    v_add_u32 v25, s51, v17
    v_add_u32 v26, s51, v18
    v_add_u32 v27, s51, v19
    v_add_u32 v28, s51, v20
    s_add_u32 s58, s58, 1
    v_mov_b64 v[152:153], 0
    v_mfma_f32_16x16x32_bf16 v[84:87], v[220:223], v[196:199], v[84:87]
    s_add_u32 s54, s54, 16384
    s_add_u32 s55, s55, s56
    v_mov_b64 v[154:155], 0
    v_mfma_f32_16x16x32_bf16 v[88:91], v[220:223], v[200:203], v[88:91]
    v_mov_b64 v[156:157], 0
    v_mfma_f32_16x16x32_bf16 v[92:95], v[220:223], v[204:207], v[92:95]
    v_mov_b64 v[158:159], 0
k2_floop:
    s_waitcnt vmcnt(12) lgkmcnt(0)
    s_barrier
    v_mfma_f32_16x16x32_bf16 v[96:99], v[176:179], v[160:163], v[96:99]
    ds_read_b64_tr_b16 v[208:209], v25 offset:0
    ds_read_b64_tr_b16 v[210:211], v25 offset:2048
    s_add_u32 m0, s50, s52
    v_mfma_f32_16x16x32_bf16 v[100:103], v[176:179], v[164:167], v[100:103]
    ds_read_b128 v[192:195], v24 offset:0
    buffer_load_dwordx4 v4, s[8:11], s54 offen sc1 lds
    v_mfma_f32_16x16x32_bf16 v[104:107], v[176:179], v[168:171], v[104:107]
    ds_read_b128 v[196:199], v24 offset:1024
    v_mfma_f32_16x16x32_bf16 v[108:111], v[176:179], v[172:175], v[108:111]
    ds_read_b128 v[200:203], v24 offset:2048
    v_mfma_f32_16x16x32_bf16 v[112:115], v[180:183], v[160:163], v[112:115]
    ds_read_b128 v[204:207], v24 offset:3072
    buffer_load_dwordx4 v4, s[8:11], s54 offen offset:1024 sc1 lds
    v_mfma_f32_16x16x32_bf16 v[116:119], v[180:183], v[164:167], v[116:119]
    ds_read_b64_tr_b16 v[212:213], v26 offset:0
    v_mfma_f32_16x16x32_bf16 v[120:123], v[180:183], v[168:171], v[120:123]
    ds_read_b64_tr_b16 v[214:215], v26 offset:2048
    s_add_u32 m0, s50, s60
    v_mfma_f32_16x16x32_bf16 v[124:127], v[180:183], v[172:175], v[124:127]
    ds_read_b64_tr_b16 v[216:217], v27 offset:0
    buffer_load_dwordx4 v5, s[12:15], s55 offen lds
    v_mfma_f32_16x16x32_bf16 v[128:131], v[184:187], v[160:163], v[128:131]
    ds_read_b64_tr_b16 v[218:219], v27 offset:2048
    v_mfma_f32_16x16x32_bf16 v[132:135], v[184:187], v[164:167], v[132:135]
    ds_read_b64_tr_b16 v[220:221], v28 offset:0
    s_add_u32 m0, s50, s61
    v_mfma_f32_16x16x32_bf16 v[136:139], v[184:187], v[168:171], v[136:139]
    ds_read_b64_tr_b16 v[222:223], v28 offset:2048
    buffer_load_dwordx4 v6, s[12:15], s55 offen lds
    v_mfma_f32_16x16x32_bf16 v[140:143], v[184:187], v[172:175], v[140:143]
    s_mov_b32 s50, s51
    s_add_u32 s51, s51, 32768
    s_cmp_eq_u32 s51, 0x28000
    s_cselect_b32 s51, 0, s51
    v_mfma_f32_16x16x32_bf16 v[144:147], v[188:191], v[160:163], v[144:147]
    v_add_u32 v24, s51, v16
    v_add_u32 v25, s51, v17
    v_add_u32 v26, s51, v18
    v_add_u32 v27, s51, v19
    v_add_u32 v28, s51, v20
    s_add_u32 s58, s58, 1
    v_mfma_f32_16x16x32_bf16 v[148:151], v[188:191], v[164:167], v[148:151]
    s_add_u32 s54, s54, 16384
    s_add_u32 s55, s55, s56
    s_cmp_ge_u32 s58, s37
    s_cselect_b32 s10, 0, s10
    s_cselect_b32 s14, 0, s14
    v_mfma_f32_16x16x32_bf16 v[152:155], v[188:191], v[168:171], v[152:155]
    s_bitcmp1_b64 s[30:31], s58
    v_mfma_f32_16x16x32_bf16 v[156:159], v[188:191], v[172:175], v[156:159]
    s_cbranch_scc1 k2_hoff
k2_roff:
    s_waitcnt vmcnt(12) lgkmcnt(0)
    s_barrier
    v_mfma_f32_16x16x32_bf16 v[96:99], v[208:211], v[192:195], v[96:99]
    ds_read_b64_tr_b16 v[176:177], v25 offset:0
    ds_read_b64_tr_b16 v[178:179], v25 offset:2048
    s_add_u32 m0, s50, s52
    v_mfma_f32_16x16x32_bf16 v[100:103], v[208:211], v[196:199], v[100:103]
    ds_read_b128 v[160:163], v24 offset:0
    buffer_load_dwordx4 v4, s[8:11], s54 offen sc1 lds
    v_mfma_f32_16x16x32_bf16 v[104:107], v[208:211], v[200:203], v[104:107]
    ds_read_b128 v[164:167], v24 offset:1024
    v_mfma_f32_16x16x32_bf16 v[108:111], v[208:211], v[204:207], v[108:111]
    ds_read_b128 v[168:171], v24 offset:2048
    v_mfma_f32_16x16x32_bf16 v[112:115], v[212:215], v[192:195], v[112:115]
    ds_read_b128 v[172:175], v24 offset:3072
    buffer_load_dwordx4 v4, s[8:11], s54 offen offset:1024 sc1 lds
    v_mfma_f32_16x16x32_bf16 v[116:119], v[212:215], v[196:199], v[116:119]
    ds_read_b64_tr_b16 v[180:181], v26 offset:0
    v_mfma_f32_16x16x32_bf16 v[120:123], v[212:215], v[200:203], v[120:123]
    ds_read_b64_tr_b16 v[182:183], v26 offset:2048
    s_add_u32 m0, s50, s60
    v_mfma_f32_16x16x32_bf16 v[124:127], v[212:215], v[204:207], v[124:127]
    ds_read_b64_tr_b16 v[184:185], v27 offset:0
    buffer_load_dwordx4 v5, s[12:15], s55 offen lds
    v_mfma_f32_16x16x32_bf16 v[128:131], v[216:219], v[192:195], v[128:131]
    ds_read_b64_tr_b16 v[186:187], v27 offset:2048
    v_mfma_f32_16x16x32_bf16 v[132:135], v[216:219], v[196:199], v[132:135]
    ds_read_b64_tr_b16 v[188:189], v28 offset:0
    s_add_u32 m0, s50, s61
    v_mfma_f32_16x16x32_bf16 v[136:139], v[216:219], v[200:203], v[136:139]
    ds_read_b64_tr_b16 v[190:191], v28 offset:2048
    buffer_load_dwordx4 v6, s[12:15], s55 offen lds
    v_mfma_f32_16x16x32_bf16 v[140:143], v[216:219], v[204:207], v[140:143]
    s_mov_b32 s50, s51
    s_add_u32 s51, s51, 32768
    s_cmp_eq_u32 s51, 0x28000
    s_cselect_b32 s51, 0, s51
    v_mfma_f32_16x16x32_bf16 v[144:147], v[220:223], v[192:195], v[144:147]
    v_add_u32 v24, s51, v16
    v_add_u32 v25, s51, v17
    v_add_u32 v26, s51, v18
    v_add_u32 v27, s51, v19
    v_add_u32 v28, s51, v20
    s_add_u32 s58, s58, 1
    v_mfma_f32_16x16x32_bf16 v[148:151], v[220:223], v[196:199], v[148:151]
    s_add_u32 s54, s54, 16384
    s_add_u32 s55, s55, s56
    v_mfma_f32_16x16x32_bf16 v[152:155], v[220:223], v[200:203], v[152:155]
    s_cmp_lt_u32 s58, s38
    v_mfma_f32_16x16x32_bf16 v[156:159], v[220:223], v[204:207], v[156:159]
    s_cbranch_scc1 k2_floop
    s_waitcnt vmcnt(0) lgkmcnt(0)
    s_barrier
    v_mfma_f32_16x16x32_bf16 v[96:99], v[176:179], v[160:163], v[96:99]
    ds_read_b64_tr_b16 v[208:209], v25 offset:0
    ds_read_b64_tr_b16 v[210:211], v25 offset:2048
    v_lshlrev_b32 v22, 2, v2
    v_mfma_f32_16x16x32_bf16 v[100:103], v[176:179], v[164:167], v[100:103]
    ds_read_b128 v[192:195], v24 offset:0
    v_lshlrev_b32 v23, 3, v3
    v_mfma_f32_16x16x32_bf16 v[104:107], v[176:179], v[168:171], v[104:107]
    ds_read_b128 v[196:199], v24 offset:1024
    v_lshl_add_u32 v21, v2, 11, v23
    v_mfma_f32_16x16x32_bf16 v[108:111], v[176:179], v[172:175], v[108:111]
    ds_read_b128 v[200:203], v24 offset:2048
    buffer_load_dword v224, v22, s[24:27], s40 offen offset:0 sc1
    v_mfma_f32_16x16x32_bf16 v[112:115], v[180:183], v[160:163], v[112:115]
    ds_read_b128 v[204:207], v24 offset:3072
    buffer_load_dword v225, v22, s[24:27], s40 offen offset:64 sc1
    v_mfma_f32_16x16x32_bf16 v[116:119], v[180:183], v[164:167], v[116:119]
    ds_read_b64_tr_b16 v[212:213], v26 offset:0
    buffer_load_dword v226, v22, s[24:27], s40 offen offset:128 sc1
    v_mfma_f32_16x16x32_bf16 v[120:123], v[180:183], v[168:171], v[120:123]
    ds_read_b64_tr_b16 v[214:215], v26 offset:2048
    buffer_load_dword v227, v22, s[24:27], s40 offen offset:192 sc1
    v_mfma_f32_16x16x32_bf16 v[124:127], v[180:183], v[172:175], v[124:127]
    ds_read_b64_tr_b16 v[216:217], v27 offset:0
    buffer_load_dword v228, v22, s[24:27], s41 offen offset:0 sc1
    v_mfma_f32_16x16x32_bf16 v[128:131], v[184:187], v[160:163], v[128:131]
    ds_read_b64_tr_b16 v[218:219], v27 offset:2048
    buffer_load_dword v229, v22, s[24:27], s41 offen offset:64 sc1
    v_mfma_f32_16x16x32_bf16 v[132:135], v[184:187], v[164:167], v[132:135]
    ds_read_b64_tr_b16 v[220:221], v28 offset:0
    buffer_load_dwordx2 v[240:241], v21, s[20:23], s42 offen offset:0
    v_mfma_f32_16x16x32_bf16 v[136:139], v[184:187], v[168:171], v[136:139]
    ds_read_b64_tr_b16 v[222:223], v28 offset:2048
    buffer_load_dwordx2 v[242:243], v21, s[20:23], s43 offen offset:0
    v_mfma_f32_16x16x32_bf16 v[140:143], v[184:187], v[172:175], v[140:143]
    buffer_load_dwordx2 v[244:245], v21, s[20:23], s42 offen offset:32
    v_mfma_f32_16x16x32_bf16 v[144:147], v[188:191], v[160:163], v[144:147]
    buffer_load_dwordx2 v[246:247], v21, s[20:23], s43 offen offset:32
    v_mfma_f32_16x16x32_bf16 v[148:151], v[188:191], v[164:167], v[148:151]
    buffer_load_dwordx2 v[248:249], v23, s[64:67], s44 offen offset:0
    v_mfma_f32_16x16x32_bf16 v[152:155], v[188:191], v[168:171], v[152:155]
    buffer_load_dwordx2 v[250:251], v23, s[64:67], s44 offen offset:32
    v_mfma_f32_16x16x32_bf16 v[156:159], v[188:191], v[172:175], v[156:159]
    s_waitcnt lgkmcnt(0)
    v_mfma_f32_16x16x32_bf16 v[96:99], v[208:211], v[192:195], v[96:99]
    v_mfma_f32_16x16x32_bf16 v[100:103], v[208:211], v[196:199], v[100:103]
    v_mfma_f32_16x16x32_bf16 v[104:107], v[208:211], v[200:203], v[104:107]
    v_mfma_f32_16x16x32_bf16 v[108:111], v[208:211], v[204:207], v[108:111]
    v_mfma_f32_16x16x32_bf16 v[112:115], v[212:215], v[192:195], v[112:115]
    v_mfma_f32_16x16x32_bf16 v[116:119], v[212:215], v[196:199], v[116:119]
    v_mfma_f32_16x16x32_bf16 v[120:123], v[212:215], v[200:203], v[120:123]
    v_mfma_f32_16x16x32_bf16 v[124:127], v[212:215], v[204:207], v[124:127]
    v_mfma_f32_16x16x32_bf16 v[128:131], v[216:219], v[192:195], v[128:131]
    v_mfma_f32_16x16x32_bf16 v[132:135], v[216:219], v[196:199], v[132:135]
    v_mfma_f32_16x16x32_bf16 v[136:139], v[216:219], v[200:203], v[136:139]
    v_mfma_f32_16x16x32_bf16 v[140:143], v[216:219], v[204:207], v[140:143]
    v_mfma_f32_16x16x32_bf16 v[144:147], v[220:223], v[192:195], v[144:147]
    v_mfma_f32_16x16x32_bf16 v[148:151], v[220:223], v[196:199], v[148:151]
    v_mfma_f32_16x16x32_bf16 v[152:155], v[220:223], v[200:203], v[152:155]
    v_mfma_f32_16x16x32_bf16 v[156:159], v[220:223], v[204:207], v[156:159]
    s_branch k2_epi
k2_hsw:
    s_cmp_lg_u32 s58, s39
    s_cbranch_scc1 k2_ev2
    s_mov_b32 s12, s90
    s_and_b32 s13, s91, 0xffff
    s_mov_b32 s55, 0
k2_ev2:
    s_cmp_eq_u32 s58, s34
    s_cbranch_scc1 k2_spre
    s_cmp_lg_u32 s58, s35
    s_cbranch_scc1 k2_rsw
    v_mov_b32 v5, v11
    v_mov_b32 v6, v12
    s_mov_b32 s12, s16
    s_mov_b32 s13, s17
    s_mov_b32 s14, s18
    s_mov_b32 s55, s45
    s_mov_b32 s56, 131072
    s_mov_b32 s60, s63
    s_add_u32 s61, s63, 8192
    s_mov_b32 s54, s62
    s_cmp_lg_u32 s3, 0
    s_cbranch_scc1 k2_rsw
    s_mov_b32 s59, 400000
    s_mov_b32 exec_lo, s80
    s_mov_b32 exec_hi, 0
k2_spoll:
    v_cmp_ne_u32 vcc, s85, v30
    s_sub_u32 s59, s59, 1
    s_cmp_eq_u32 s59, 0
    s_cbranch_scc1 k2_sok
    s_nop 2
    s_cbranch_vccz k2_sok
    buffer_load_dword v30, v29, s[24:27], s57 offen sc1
    s_waitcnt vmcnt(0)
    s_branch k2_spoll
k2_spre:
    s_cmp_lg_u32 s3, 0
    s_cbranch_scc1 k2_rsw
    s_mov_b64 exec, 0xffff
    buffer_load_dword v30, v29, s[24:27], s57 offen sc1
k2_sok:
    s_mov_b64 exec, -1
    s_branch k2_rsw
k2_hoff:
    s_cmp_lg_u32 s3, 0
    s_cbranch_scc1 k2_roff
    s_cmp_eq_u32 s58, s82
    s_cbranch_scc1 k2_t2p
    s_cmp_lg_u32 s58, s83
    s_cbranch_scc1 k2_roff
    s_mov_b32 s59, 400000
    s_mov_b32 exec_lo, s81
    s_mov_b32 exec_hi, 0
k2_t2l:
    v_cmp_ne_u32 vcc, s85, v30
    s_sub_u32 s59, s59, 1
    s_cmp_eq_u32 s59, 0
    s_cbranch_scc1 k2_t2k
    s_nop 2
    s_cbranch_vccz k2_t2k
    buffer_load_dword v30, v29, s[24:27], s57 offen sc1
    s_waitcnt vmcnt(0)
    s_branch k2_t2l
k2_t2p:
    s_mov_b64 exec, 0xffff
    buffer_load_dword v30, v29, s[24:27], s57 offen sc1
k2_t2k:
    s_mov_b64 exec, -1
    s_branch k2_roff
k2_epi:
    s_waitcnt vmcnt(0)
    s_barrier
    v_sub_f32 v11, 1.0, v224
    v_cvt_pk_bf16_f32 v11, v11, v11
    v_and_b32 v11, 0xffff0000, v11
    v_add_f32 v224, v224, v224
    v_sub_f32 v12, 1.0, v225
    v_cvt_pk_bf16_f32 v12, v12, v12
    v_and_b32 v12, 0xffff0000, v12
    v_add_f32 v225, v225, v225
    v_sub_f32 v22, 1.0, v226
    v_cvt_pk_bf16_f32 v22, v22, v22
    v_and_b32 v22, 0xffff0000, v22
    v_add_f32 v226, v226, v226
    v_sub_f32 v23, 1.0, v227
    v_cvt_pk_bf16_f32 v23, v23, v23
    v_and_b32 v23, 0xffff0000, v23
    v_add_f32 v227, v227, v227
    v_lshlrev_b32 v4, 4, v1
    s_lshl_b32 s48, s3, 13
    v_add_u32 v5, s48, v4
    s_xor_b32 s48, s48, 0x8000
    v_add_u32 v6, s48, v4
    s_lshl_b32 s48, s75, 1
    s_add_u32 s48, s48, s72
    s_lshl_b32 s49, s2, 15
    s_lshl_b32 s50, s3, 12
    s_add_u32 s49, s49, s50
    s_add_u32 s49, s49, 33554432
k2_var0:
    s_cmp_lg_u32 s48, 0
    s_cbranch_scc1 k2_var1
    v_mul_f32 v104, v104, v22
    v_fma_f32 v40, v40, v226, v104
    v_mul_f32 v105, v105, v22
    v_fma_f32 v41, v41, v226, v105
    v_mul_f32 v106, v106, v22
    v_fma_f32 v42, v42, v226, v106
    v_mul_f32 v107, v107, v22
    v_fma_f32 v43, v43, v226, v107
    ds_write_b128 v5, v[40:43] offset:0
    v_mul_f32 v108, v108, v23
    v_fma_f32 v44, v44, v227, v108
    v_mul_f32 v109, v109, v23
    v_fma_f32 v45, v45, v227, v109
    v_mul_f32 v110, v110, v23
    v_fma_f32 v46, v46, v227, v110
    v_mul_f32 v111, v111, v23
    v_fma_f32 v47, v47, v227, v111
    ds_write_b128 v5, v[44:47] offset:1024
    v_mul_f32 v120, v120, v22
    v_fma_f32 v56, v56, v226, v120
    v_mul_f32 v121, v121, v22
    v_fma_f32 v57, v57, v226, v121
    v_mul_f32 v122, v122, v22
    v_fma_f32 v58, v58, v226, v122
    v_mul_f32 v123, v123, v22
    v_fma_f32 v59, v59, v226, v123
    ds_write_b128 v5, v[56:59] offset:2048
    v_mul_f32 v124, v124, v23
    v_fma_f32 v60, v60, v227, v124
    v_mul_f32 v125, v125, v23
    v_fma_f32 v61, v61, v227, v125
    v_mul_f32 v126, v126, v23
    v_fma_f32 v62, v62, v227, v126
    v_mul_f32 v127, v127, v23
    v_fma_f32 v63, v63, v227, v127
    ds_write_b128 v5, v[60:63] offset:3072
    v_mul_f32 v136, v136, v22
    v_fma_f32 v72, v72, v226, v136
    v_mul_f32 v137, v137, v22
    v_fma_f32 v73, v73, v226, v137
    v_mul_f32 v138, v138, v22
    v_fma_f32 v74, v74, v226, v138
    v_mul_f32 v139, v139, v22
    v_fma_f32 v75, v75, v226, v139
    ds_write_b128 v5, v[72:75] offset:4096
    v_mul_f32 v140, v140, v23
    v_fma_f32 v76, v76, v227, v140
    v_mul_f32 v141, v141, v23
    v_fma_f32 v77, v77, v227, v141
    v_mul_f32 v142, v142, v23
    v_fma_f32 v78, v78, v227, v142
    v_mul_f32 v143, v143, v23
    v_fma_f32 v79, v79, v227, v143
    ds_write_b128 v5, v[76:79] offset:5120
    v_mul_f32 v152, v152, v22
    v_fma_f32 v88, v88, v226, v152
    v_mul_f32 v153, v153, v22
    v_fma_f32 v89, v89, v226, v153
    v_mul_f32 v154, v154, v22
    v_fma_f32 v90, v90, v226, v154
    v_mul_f32 v155, v155, v22
    v_fma_f32 v91, v91, v226, v155
    ds_write_b128 v5, v[88:91] offset:6144
    v_mul_f32 v156, v156, v23
    v_fma_f32 v92, v92, v227, v156
    v_mul_f32 v157, v157, v23
    v_fma_f32 v93, v93, v227, v157
    v_mul_f32 v158, v158, v23
    v_fma_f32 v94, v94, v227, v158
    v_mul_f32 v159, v159, v23
    v_fma_f32 v95, v95, v227, v159
    ds_write_b128 v5, v[92:95] offset:7168
    v_mul_f32 v96, v96, v11
    v_fma_f32 v32, v32, v224, v96
    v_mul_f32 v97, v97, v11
    v_fma_f32 v33, v33, v224, v97
    v_mul_f32 v98, v98, v11
    v_fma_f32 v34, v34, v224, v98
    v_mul_f32 v99, v99, v11
    v_fma_f32 v35, v35, v224, v99
    v_mul_f32 v100, v100, v12
    v_fma_f32 v36, v36, v225, v100
    v_mul_f32 v101, v101, v12
    v_fma_f32 v37, v37, v225, v101
    v_mul_f32 v102, v102, v12
    v_fma_f32 v38, v38, v225, v102
    v_mul_f32 v103, v103, v12
    v_fma_f32 v39, v39, v225, v103
    v_mul_f32 v112, v112, v11
    v_fma_f32 v48, v48, v224, v112
    v_mul_f32 v113, v113, v11
    v_fma_f32 v49, v49, v224, v113
    v_mul_f32 v114, v114, v11
    v_fma_f32 v50, v50, v224, v114
    v_mul_f32 v115, v115, v11
    v_fma_f32 v51, v51, v224, v115
    v_mul_f32 v116, v116, v12
    v_fma_f32 v52, v52, v225, v116
    v_mul_f32 v117, v117, v12
    v_fma_f32 v53, v53, v225, v117
    v_mul_f32 v118, v118, v12
    v_fma_f32 v54, v54, v225, v118
    v_mul_f32 v119, v119, v12
    v_fma_f32 v55, v55, v225, v119
    v_mul_f32 v128, v128, v11
    v_fma_f32 v64, v64, v224, v128
    v_mul_f32 v129, v129, v11
    v_fma_f32 v65, v65, v224, v129
    v_mul_f32 v130, v130, v11
    v_fma_f32 v66, v66, v224, v130
    v_mul_f32 v131, v131, v11
    v_fma_f32 v67, v67, v224, v131
    v_mul_f32 v132, v132, v12
    v_fma_f32 v68, v68, v225, v132
    v_mul_f32 v133, v133, v12
    v_fma_f32 v69, v69, v225, v133
    v_mul_f32 v134, v134, v12
    v_fma_f32 v70, v70, v225, v134
    v_mul_f32 v135, v135, v12
    v_fma_f32 v71, v71, v225, v135
    v_mul_f32 v144, v144, v11
    v_fma_f32 v80, v80, v224, v144
    v_mul_f32 v145, v145, v11
    v_fma_f32 v81, v81, v224, v145
    v_mul_f32 v146, v146, v11
    v_fma_f32 v82, v82, v224, v146
    v_mul_f32 v147, v147, v11
    v_fma_f32 v83, v83, v224, v147
    v_mul_f32 v148, v148, v12
    v_fma_f32 v84, v84, v225, v148
    v_mul_f32 v149, v149, v12
    v_fma_f32 v85, v85, v225, v149
    v_mul_f32 v150, v150, v12
    v_fma_f32 v86, v86, v225, v150
    v_mul_f32 v151, v151, v12
    v_fma_f32 v87, v87, v225, v151
    s_waitcnt lgkmcnt(0)
    s_barrier
    ds_read_b128 v[176:179], v6 offset:4096
    ds_read_b128 v[180:183], v6 offset:5120
    ds_read_b128 v[184:187], v6 offset:6144
    ds_read_b128 v[188:191], v6 offset:7168
    ds_read_b128 v[160:163], v6 offset:0
    ds_read_b128 v[164:167], v6 offset:1024
    ds_read_b128 v[168:171], v6 offset:2048
    ds_read_b128 v[172:175], v6 offset:3072
    s_waitcnt lgkmcnt(7)
    v_add_f32 v192, v64, v176
    v_add_f32 v193, v65, v177
    v_add_f32 v194, v66, v178
    v_add_f32 v195, v67, v179
    buffer_store_dwordx4 v[192:195], v4, s[24:27], s49 offen offset:0 sc1
    s_waitcnt lgkmcnt(6)
    v_add_f32 v196, v68, v180
    v_add_f32 v197, v69, v181
    v_add_f32 v198, v70, v182
    v_add_f32 v199, v71, v183
    buffer_store_dwordx4 v[196:199], v4, s[24:27], s49 offen offset:1024 sc1
    s_waitcnt lgkmcnt(5)
    v_add_f32 v200, v80, v184
    v_add_f32 v201, v81, v185
    v_add_f32 v202, v82, v186
    v_add_f32 v203, v83, v187
    buffer_store_dwordx4 v[200:203], v4, s[24:27], s49 offen offset:2048 sc1
    s_waitcnt lgkmcnt(4)
    v_add_f32 v204, v84, v188
    v_add_f32 v205, v85, v189
    v_add_f32 v206, v86, v190
    v_add_f32 v207, v87, v191
    buffer_store_dwordx4 v[204:207], v4, s[24:27], s49 offen offset:3072 sc1
    s_waitcnt lgkmcnt(3)
    v_add_f32 v208, v32, v160
    v_add_f32 v209, v33, v161
    v_add_f32 v210, v34, v162
    v_add_f32 v211, v35, v163
    s_waitcnt lgkmcnt(2)
    v_add_f32 v212, v36, v164
    v_add_f32 v213, v37, v165
    v_add_f32 v214, v38, v166
    v_add_f32 v215, v39, v167
    s_waitcnt lgkmcnt(1)
    v_add_f32 v216, v48, v168
    v_add_f32 v217, v49, v169
    v_add_f32 v218, v50, v170
    v_add_f32 v219, v51, v171
    s_waitcnt lgkmcnt(0)
    v_add_f32 v220, v52, v172
    v_add_f32 v221, v53, v173
    v_add_f32 v222, v54, v174
    v_add_f32 v223, v55, v175
    s_branch k2_common
k2_var1:
    s_cmp_lg_u32 s48, 1
    s_cbranch_scc1 k2_var2
    v_mul_f32 v104, v104, v22
    v_fma_f32 v40, v40, v226, v104
    v_mul_f32 v105, v105, v22
    v_fma_f32 v41, v41, v226, v105
    v_mul_f32 v106, v106, v22
    v_fma_f32 v42, v42, v226, v106
    v_mul_f32 v107, v107, v22
    v_fma_f32 v43, v43, v226, v107
    ds_write_b128 v5, v[40:43] offset:0
    v_mul_f32 v108, v108, v23
    v_fma_f32 v44, v44, v227, v108
    v_mul_f32 v109, v109, v23
    v_fma_f32 v45, v45, v227, v109
    v_mul_f32 v110, v110, v23
    v_fma_f32 v46, v46, v227, v110
    v_mul_f32 v111, v111, v23
    v_fma_f32 v47, v47, v227, v111
    ds_write_b128 v5, v[44:47] offset:1024
    v_mul_f32 v120, v120, v22
    v_fma_f32 v56, v56, v226, v120
    v_mul_f32 v121, v121, v22
    v_fma_f32 v57, v57, v226, v121
    v_mul_f32 v122, v122, v22
    v_fma_f32 v58, v58, v226, v122
    v_mul_f32 v123, v123, v22
    v_fma_f32 v59, v59, v226, v123
    ds_write_b128 v5, v[56:59] offset:2048
    v_mul_f32 v124, v124, v23
    v_fma_f32 v60, v60, v227, v124
    v_mul_f32 v125, v125, v23
    v_fma_f32 v61, v61, v227, v125
    v_mul_f32 v126, v126, v23
    v_fma_f32 v62, v62, v227, v126
    v_mul_f32 v127, v127, v23
    v_fma_f32 v63, v63, v227, v127
    ds_write_b128 v5, v[60:63] offset:3072
    v_mul_f32 v136, v136, v22
    v_fma_f32 v72, v72, v226, v136
    v_mul_f32 v137, v137, v22
    v_fma_f32 v73, v73, v226, v137
    v_mul_f32 v138, v138, v22
    v_fma_f32 v74, v74, v226, v138
    v_mul_f32 v139, v139, v22
    v_fma_f32 v75, v75, v226, v139
    ds_write_b128 v5, v[72:75] offset:4096
    v_mul_f32 v140, v140, v23
    v_fma_f32 v76, v76, v227, v140
    v_mul_f32 v141, v141, v23
    v_fma_f32 v77, v77, v227, v141
    v_mul_f32 v142, v142, v23
    v_fma_f32 v78, v78, v227, v142
    v_mul_f32 v143, v143, v23
    v_fma_f32 v79, v79, v227, v143
    ds_write_b128 v5, v[76:79] offset:5120
    v_mul_f32 v152, v152, v22
    v_fma_f32 v88, v88, v226, v152
    v_mul_f32 v153, v153, v22
    v_fma_f32 v89, v89, v226, v153
    v_mul_f32 v154, v154, v22
    v_fma_f32 v90, v90, v226, v154
    v_mul_f32 v155, v155, v22
    v_fma_f32 v91, v91, v226, v155
    ds_write_b128 v5, v[88:91] offset:6144
    v_mul_f32 v156, v156, v23
    v_fma_f32 v92, v92, v227, v156
    v_mul_f32 v157, v157, v23
    v_fma_f32 v93, v93, v227, v157
    v_mul_f32 v158, v158, v23
    v_fma_f32 v94, v94, v227, v158
    v_mul_f32 v159, v159, v23
    v_fma_f32 v95, v95, v227, v159
    ds_write_b128 v5, v[92:95] offset:7168
    v_mul_f32 v96, v96, v11
    v_fma_f32 v32, v32, v224, v96
    v_mul_f32 v97, v97, v11
    v_fma_f32 v33, v33, v224, v97
    v_mul_f32 v98, v98, v11
    v_fma_f32 v34, v34, v224, v98
    v_mul_f32 v99, v99, v11
    v_fma_f32 v35, v35, v224, v99
    v_mul_f32 v100, v100, v12
    v_fma_f32 v36, v36, v225, v100
    v_mul_f32 v101, v101, v12
    v_fma_f32 v37, v37, v225, v101
    v_mul_f32 v102, v102, v12
    v_fma_f32 v38, v38, v225, v102
    v_mul_f32 v103, v103, v12
    v_fma_f32 v39, v39, v225, v103
    v_mul_f32 v112, v112, v11
    v_fma_f32 v48, v48, v224, v112
    v_mul_f32 v113, v113, v11
    v_fma_f32 v49, v49, v224, v113
    v_mul_f32 v114, v114, v11
    v_fma_f32 v50, v50, v224, v114
    v_mul_f32 v115, v115, v11
    v_fma_f32 v51, v51, v224, v115
    v_mul_f32 v116, v116, v12
    v_fma_f32 v52, v52, v225, v116
    v_mul_f32 v117, v117, v12
    v_fma_f32 v53, v53, v225, v117
    v_mul_f32 v118, v118, v12
    v_fma_f32 v54, v54, v225, v118
    v_mul_f32 v119, v119, v12
    v_fma_f32 v55, v55, v225, v119
    v_mul_f32 v128, v128, v11
    v_fma_f32 v64, v64, v224, v128
    v_mul_f32 v129, v129, v11
    v_fma_f32 v65, v65, v224, v129
    v_mul_f32 v130, v130, v11
    v_fma_f32 v66, v66, v224, v130
    v_mul_f32 v131, v131, v11
    v_fma_f32 v67, v67, v224, v131
    v_mul_f32 v132, v132, v12
    v_fma_f32 v68, v68, v225, v132
    v_mul_f32 v133, v133, v12
    v_fma_f32 v69, v69, v225, v133
    v_mul_f32 v134, v134, v12
    v_fma_f32 v70, v70, v225, v134
    v_mul_f32 v135, v135, v12
    v_fma_f32 v71, v71, v225, v135
    v_mul_f32 v144, v144, v11
    v_fma_f32 v80, v80, v224, v144
    v_mul_f32 v145, v145, v11
    v_fma_f32 v81, v81, v224, v145
    v_mul_f32 v146, v146, v11
    v_fma_f32 v82, v82, v224, v146
    v_mul_f32 v147, v147, v11
    v_fma_f32 v83, v83, v224, v147
    v_mul_f32 v148, v148, v12
    v_fma_f32 v84, v84, v225, v148
    v_mul_f32 v149, v149, v12
    v_fma_f32 v85, v85, v225, v149
    v_mul_f32 v150, v150, v12
    v_fma_f32 v86, v86, v225, v150
    v_mul_f32 v151, v151, v12
    v_fma_f32 v87, v87, v225, v151
    s_waitcnt lgkmcnt(0)
    s_barrier
    ds_read_b128 v[160:163], v6 offset:0
    ds_read_b128 v[164:167], v6 offset:1024
    ds_read_b128 v[168:171], v6 offset:2048
    ds_read_b128 v[172:175], v6 offset:3072
    ds_read_b128 v[176:179], v6 offset:4096
    ds_read_b128 v[180:183], v6 offset:5120
    ds_read_b128 v[184:187], v6 offset:6144
    ds_read_b128 v[188:191], v6 offset:7168
    s_waitcnt lgkmcnt(7)
    v_add_f32 v192, v32, v160
    v_add_f32 v193, v33, v161
    v_add_f32 v194, v34, v162
    v_add_f32 v195, v35, v163
    buffer_store_dwordx4 v[192:195], v4, s[24:27], s49 offen offset:0 sc1
    s_waitcnt lgkmcnt(6)
    v_add_f32 v196, v36, v164
    v_add_f32 v197, v37, v165
    v_add_f32 v198, v38, v166
    v_add_f32 v199, v39, v167
    buffer_store_dwordx4 v[196:199], v4, s[24:27], s49 offen offset:1024 sc1
    s_waitcnt lgkmcnt(5)
    v_add_f32 v200, v48, v168
    v_add_f32 v201, v49, v169
    v_add_f32 v202, v50, v170
    v_add_f32 v203, v51, v171
    buffer_store_dwordx4 v[200:203], v4, s[24:27], s49 offen offset:2048 sc1
    s_waitcnt lgkmcnt(4)
    v_add_f32 v204, v52, v172
    v_add_f32 v205, v53, v173
    v_add_f32 v206, v54, v174
    v_add_f32 v207, v55, v175
    buffer_store_dwordx4 v[204:207], v4, s[24:27], s49 offen offset:3072 sc1
    s_waitcnt lgkmcnt(3)
    v_add_f32 v208, v64, v176
    v_add_f32 v209, v65, v177
    v_add_f32 v210, v66, v178
    v_add_f32 v211, v67, v179
    s_waitcnt lgkmcnt(2)
    v_add_f32 v212, v68, v180
    v_add_f32 v213, v69, v181
    v_add_f32 v214, v70, v182
    v_add_f32 v215, v71, v183
    s_waitcnt lgkmcnt(1)
    v_add_f32 v216, v80, v184
    v_add_f32 v217, v81, v185
    v_add_f32 v218, v82, v186
    v_add_f32 v219, v83, v187
    s_waitcnt lgkmcnt(0)
    v_add_f32 v220, v84, v188
    v_add_f32 v221, v85, v189
    v_add_f32 v222, v86, v190
    v_add_f32 v223, v87, v191
    s_branch k2_common
k2_var2:
    s_cmp_lg_u32 s48, 2
    s_cbranch_scc1 k2_var3
    v_mul_f32 v96, v96, v11
    v_fma_f32 v32, v32, v224, v96
    v_mul_f32 v97, v97, v11
    v_fma_f32 v33, v33, v224, v97
    v_mul_f32 v98, v98, v11
    v_fma_f32 v34, v34, v224, v98
    v_mul_f32 v99, v99, v11
    v_fma_f32 v35, v35, v224, v99
    ds_write_b128 v5, v[32:35] offset:0
    v_mul_f32 v100, v100, v12
    v_fma_f32 v36, v36, v225, v100
    v_mul_f32 v101, v101, v12
    v_fma_f32 v37, v37, v225, v101
    v_mul_f32 v102, v102, v12
    v_fma_f32 v38, v38, v225, v102
    v_mul_f32 v103, v103, v12
    v_fma_f32 v39, v39, v225, v103
    ds_write_b128 v5, v[36:39] offset:1024
    v_mul_f32 v112, v112, v11
    v_fma_f32 v48, v48, v224, v112
    v_mul_f32 v113, v113, v11
    v_fma_f32 v49, v49, v224, v113
    v_mul_f32 v114, v114, v11
    v_fma_f32 v50, v50, v224, v114
    v_mul_f32 v115, v115, v11
    v_fma_f32 v51, v51, v224, v115
    ds_write_b128 v5, v[48:51] offset:2048
    v_mul_f32 v116, v116, v12
    v_fma_f32 v52, v52, v225, v116
    v_mul_f32 v117, v117, v12
    v_fma_f32 v53, v53, v225, v117
    v_mul_f32 v118, v118, v12
    v_fma_f32 v54, v54, v225, v118
    v_mul_f32 v119, v119, v12
    v_fma_f32 v55, v55, v225, v119
    ds_write_b128 v5, v[52:55] offset:3072
    v_mul_f32 v128, v128, v11
    v_fma_f32 v64, v64, v224, v128
    v_mul_f32 v129, v129, v11
    v_fma_f32 v65, v65, v224, v129
    v_mul_f32 v130, v130, v11
    v_fma_f32 v66, v66, v224, v130
    v_mul_f32 v131, v131, v11
    v_fma_f32 v67, v67, v224, v131
    ds_write_b128 v5, v[64:67] offset:4096
    v_mul_f32 v132, v132, v12
    v_fma_f32 v68, v68, v225, v132
    v_mul_f32 v133, v133, v12
    v_fma_f32 v69, v69, v225, v133
    v_mul_f32 v134, v134, v12
    v_fma_f32 v70, v70, v225, v134
    v_mul_f32 v135, v135, v12
    v_fma_f32 v71, v71, v225, v135
    ds_write_b128 v5, v[68:71] offset:5120
    v_mul_f32 v144, v144, v11
    v_fma_f32 v80, v80, v224, v144
    v_mul_f32 v145, v145, v11
    v_fma_f32 v81, v81, v224, v145
    v_mul_f32 v146, v146, v11
    v_fma_f32 v82, v82, v224, v146
    v_mul_f32 v147, v147, v11
    v_fma_f32 v83, v83, v224, v147
    ds_write_b128 v5, v[80:83] offset:6144
    v_mul_f32 v148, v148, v12
    v_fma_f32 v84, v84, v225, v148
    v_mul_f32 v149, v149, v12
    v_fma_f32 v85, v85, v225, v149
    v_mul_f32 v150, v150, v12
    v_fma_f32 v86, v86, v225, v150
    v_mul_f32 v151, v151, v12
    v_fma_f32 v87, v87, v225, v151
    ds_write_b128 v5, v[84:87] offset:7168
    v_mul_f32 v104, v104, v22
    v_fma_f32 v40, v40, v226, v104
    v_mul_f32 v105, v105, v22
    v_fma_f32 v41, v41, v226, v105
    v_mul_f32 v106, v106, v22
    v_fma_f32 v42, v42, v226, v106
    v_mul_f32 v107, v107, v22
    v_fma_f32 v43, v43, v226, v107
    v_mul_f32 v108, v108, v23
    v_fma_f32 v44, v44, v227, v108
    v_mul_f32 v109, v109, v23
    v_fma_f32 v45, v45, v227, v109
    v_mul_f32 v110, v110, v23
    v_fma_f32 v46, v46, v227, v110
    v_mul_f32 v111, v111, v23
    v_fma_f32 v47, v47, v227, v111
    v_mul_f32 v120, v120, v22
    v_fma_f32 v56, v56, v226, v120
    v_mul_f32 v121, v121, v22
    v_fma_f32 v57, v57, v226, v121
    v_mul_f32 v122, v122, v22
    v_fma_f32 v58, v58, v226, v122
    v_mul_f32 v123, v123, v22
    v_fma_f32 v59, v59, v226, v123
    v_mul_f32 v124, v124, v23
    v_fma_f32 v60, v60, v227, v124
    v_mul_f32 v125, v125, v23
    v_fma_f32 v61, v61, v227, v125
    v_mul_f32 v126, v126, v23
    v_fma_f32 v62, v62, v227, v126
    v_mul_f32 v127, v127, v23
    v_fma_f32 v63, v63, v227, v127
    v_mul_f32 v136, v136, v22
    v_fma_f32 v72, v72, v226, v136
    v_mul_f32 v137, v137, v22
    v_fma_f32 v73, v73, v226, v137
    v_mul_f32 v138, v138, v22
    v_fma_f32 v74, v74, v226, v138
    v_mul_f32 v139, v139, v22
    v_fma_f32 v75, v75, v226, v139
    v_mul_f32 v140, v140, v23
    v_fma_f32 v76, v76, v227, v140
    v_mul_f32 v141, v141, v23
    v_fma_f32 v77, v77, v227, v141
    v_mul_f32 v142, v142, v23
    v_fma_f32 v78, v78, v227, v142
    v_mul_f32 v143, v143, v23
    v_fma_f32 v79, v79, v227, v143
    v_mul_f32 v152, v152, v22
    v_fma_f32 v88, v88, v226, v152
    v_mul_f32 v153, v153, v22
    v_fma_f32 v89, v89, v226, v153
    v_mul_f32 v154, v154, v22
    v_fma_f32 v90, v90, v226, v154
    v_mul_f32 v155, v155, v22
    v_fma_f32 v91, v91, v226, v155
    v_mul_f32 v156, v156, v23
    v_fma_f32 v92, v92, v227, v156
    v_mul_f32 v157, v157, v23
    v_fma_f32 v93, v93, v227, v157
    v_mul_f32 v158, v158, v23
    v_fma_f32 v94, v94, v227, v158
    v_mul_f32 v159, v159, v23
    v_fma_f32 v95, v95, v227, v159
    s_waitcnt lgkmcnt(0)
    s_barrier
    ds_read_b128 v[176:179], v6 offset:4096
    ds_read_b128 v[180:183], v6 offset:5120
    ds_read_b128 v[184:187], v6 offset:6144
    ds_read_b128 v[188:191], v6 offset:7168
    ds_read_b128 v[160:163], v6 offset:0
    ds_read_b128 v[164:167], v6 offset:1024
    ds_read_b128 v[168:171], v6 offset:2048
    ds_read_b128 v[172:175], v6 offset:3072
    s_waitcnt lgkmcnt(7)
    v_add_f32 v192, v72, v176
    v_add_f32 v193, v73, v177
    v_add_f32 v194, v74, v178
    v_add_f32 v195, v75, v179
    buffer_store_dwordx4 v[192:195], v4, s[24:27], s49 offen offset:0 sc1
    s_waitcnt lgkmcnt(6)
    v_add_f32 v196, v76, v180
    v_add_f32 v197, v77, v181
    v_add_f32 v198, v78, v182
    v_add_f32 v199, v79, v183
    buffer_store_dwordx4 v[196:199], v4, s[24:27], s49 offen offset:1024 sc1
    s_waitcnt lgkmcnt(5)
    v_add_f32 v200, v88, v184
    v_add_f32 v201, v89, v185
    v_add_f32 v202, v90, v186
    v_add_f32 v203, v91, v187
    buffer_store_dwordx4 v[200:203], v4, s[24:27], s49 offen offset:2048 sc1
    s_waitcnt lgkmcnt(4)
    v_add_f32 v204, v92, v188
    v_add_f32 v205, v93, v189
    v_add_f32 v206, v94, v190
    v_add_f32 v207, v95, v191
    buffer_store_dwordx4 v[204:207], v4, s[24:27], s49 offen offset:3072 sc1
    s_waitcnt lgkmcnt(3)
    v_add_f32 v208, v40, v160
    v_add_f32 v209, v41, v161
    v_add_f32 v210, v42, v162
    v_add_f32 v211, v43, v163
    s_waitcnt lgkmcnt(2)
    v_add_f32 v212, v44, v164
    v_add_f32 v213, v45, v165
    v_add_f32 v214, v46, v166
    v_add_f32 v215, v47, v167
    s_waitcnt lgkmcnt(1)
    v_add_f32 v216, v56, v168
    v_add_f32 v217, v57, v169
    v_add_f32 v218, v58, v170
    v_add_f32 v219, v59, v171
    s_waitcnt lgkmcnt(0)
    v_add_f32 v220, v60, v172
    v_add_f32 v221, v61, v173
    v_add_f32 v222, v62, v174
    v_add_f32 v223, v63, v175
    s_branch k2_common
k2_var3:
    v_mul_f32 v96, v96, v11
    v_fma_f32 v32, v32, v224, v96
    v_mul_f32 v97, v97, v11
    v_fma_f32 v33, v33, v224, v97
    v_mul_f32 v98, v98, v11
    v_fma_f32 v34, v34, v224, v98
    v_mul_f32 v99, v99, v11
    v_fma_f32 v35, v35, v224, v99
    ds_write_b128 v5, v[32:35] offset:0
    v_mul_f32 v100, v100, v12
    v_fma_f32 v36, v36, v225, v100
    v_mul_f32 v101, v101, v12
    v_fma_f32 v37, v37, v225, v101
    v_mul_f32 v102, v102, v12
    v_fma_f32 v38, v38, v225, v102
    v_mul_f32 v103, v103, v12
    v_fma_f32 v39, v39, v225, v103
    ds_write_b128 v5, v[36:39] offset:1024
    v_mul_f32 v112, v112, v11
    v_fma_f32 v48, v48, v224, v112
    v_mul_f32 v113, v113, v11
    v_fma_f32 v49, v49, v224, v113
    v_mul_f32 v114, v114, v11
    v_fma_f32 v50, v50, v224, v114
    v_mul_f32 v115, v115, v11
    v_fma_f32 v51, v51, v224, v115
    ds_write_b128 v5, v[48:51] offset:2048
    v_mul_f32 v116, v116, v12
    v_fma_f32 v52, v52, v225, v116
    v_mul_f32 v117, v117, v12
    v_fma_f32 v53, v53, v225, v117
    v_mul_f32 v118, v118, v12
    v_fma_f32 v54, v54, v225, v118
    v_mul_f32 v119, v119, v12
    v_fma_f32 v55, v55, v225, v119
    ds_write_b128 v5, v[52:55] offset:3072
    v_mul_f32 v128, v128, v11
    v_fma_f32 v64, v64, v224, v128
    v_mul_f32 v129, v129, v11
    v_fma_f32 v65, v65, v224, v129
    v_mul_f32 v130, v130, v11
    v_fma_f32 v66, v66, v224, v130
    v_mul_f32 v131, v131, v11
    v_fma_f32 v67, v67, v224, v131
    ds_write_b128 v5, v[64:67] offset:4096
    v_mul_f32 v132, v132, v12
    v_fma_f32 v68, v68, v225, v132
    v_mul_f32 v133, v133, v12
    v_fma_f32 v69, v69, v225, v133
    v_mul_f32 v134, v134, v12
    v_fma_f32 v70, v70, v225, v134
    v_mul_f32 v135, v135, v12
    v_fma_f32 v71, v71, v225, v135
    ds_write_b128 v5, v[68:71] offset:5120
    v_mul_f32 v144, v144, v11
    v_fma_f32 v80, v80, v224, v144
    v_mul_f32 v145, v145, v11
    v_fma_f32 v81, v81, v224, v145
    v_mul_f32 v146, v146, v11
    v_fma_f32 v82, v82, v224, v146
    v_mul_f32 v147, v147, v11
    v_fma_f32 v83, v83, v224, v147
    ds_write_b128 v5, v[80:83] offset:6144
    v_mul_f32 v148, v148, v12
    v_fma_f32 v84, v84, v225, v148
    v_mul_f32 v149, v149, v12
    v_fma_f32 v85, v85, v225, v149
    v_mul_f32 v150, v150, v12
    v_fma_f32 v86, v86, v225, v150
    v_mul_f32 v151, v151, v12
    v_fma_f32 v87, v87, v225, v151
    ds_write_b128 v5, v[84:87] offset:7168
    v_mul_f32 v104, v104, v22
    v_fma_f32 v40, v40, v226, v104
    v_mul_f32 v105, v105, v22
    v_fma_f32 v41, v41, v226, v105
    v_mul_f32 v106, v106, v22
    v_fma_f32 v42, v42, v226, v106
    v_mul_f32 v107, v107, v22
    v_fma_f32 v43, v43, v226, v107
    v_mul_f32 v108, v108, v23
    v_fma_f32 v44, v44, v227, v108
    v_mul_f32 v109, v109, v23
    v_fma_f32 v45, v45, v227, v109
    v_mul_f32 v110, v110, v23
    v_fma_f32 v46, v46, v227, v110
    v_mul_f32 v111, v111, v23
    v_fma_f32 v47, v47, v227, v111
    v_mul_f32 v120, v120, v22
    v_fma_f32 v56, v56, v226, v120
    v_mul_f32 v121, v121, v22
    v_fma_f32 v57, v57, v226, v121
    v_mul_f32 v122, v122, v22
    v_fma_f32 v58, v58, v226, v122
    v_mul_f32 v123, v123, v22
    v_fma_f32 v59, v59, v226, v123
    v_mul_f32 v124, v124, v23
    v_fma_f32 v60, v60, v227, v124
    v_mul_f32 v125, v125, v23
    v_fma_f32 v61, v61, v227, v125
    v_mul_f32 v126, v126, v23
    v_fma_f32 v62, v62, v227, v126
    v_mul_f32 v127, v127, v23
    v_fma_f32 v63, v63, v227, v127
    v_mul_f32 v136, v136, v22
    v_fma_f32 v72, v72, v226, v136
    v_mul_f32 v137, v137, v22
    v_fma_f32 v73, v73, v226, v137
    v_mul_f32 v138, v138, v22
    v_fma_f32 v74, v74, v226, v138
    v_mul_f32 v139, v139, v22
    v_fma_f32 v75, v75, v226, v139
    v_mul_f32 v140, v140, v23
    v_fma_f32 v76, v76, v227, v140
    v_mul_f32 v141, v141, v23
    v_fma_f32 v77, v77, v227, v141
    v_mul_f32 v142, v142, v23
    v_fma_f32 v78, v78, v227, v142
    v_mul_f32 v143, v143, v23
    v_fma_f32 v79, v79, v227, v143
    v_mul_f32 v152, v152, v22
    v_fma_f32 v88, v88, v226, v152
    v_mul_f32 v153, v153, v22
    v_fma_f32 v89, v89, v226, v153
    v_mul_f32 v154, v154, v22
    v_fma_f32 v90, v90, v226, v154
    v_mul_f32 v155, v155, v22
    v_fma_f32 v91, v91, v226, v155
    v_mul_f32 v156, v156, v23
    v_fma_f32 v92, v92, v227, v156
    v_mul_f32 v157, v157, v23
    v_fma_f32 v93, v93, v227, v157
    v_mul_f32 v158, v158, v23
    v_fma_f32 v94, v94, v227, v158
    v_mul_f32 v159, v159, v23
    v_fma_f32 v95, v95, v227, v159
    s_waitcnt lgkmcnt(0)
    s_barrier
    ds_read_b128 v[160:163], v6 offset:0
    ds_read_b128 v[164:167], v6 offset:1024
    ds_read_b128 v[168:171], v6 offset:2048
    ds_read_b128 v[172:175], v6 offset:3072
    ds_read_b128 v[176:179], v6 offset:4096
    ds_read_b128 v[180:183], v6 offset:5120
    ds_read_b128 v[184:187], v6 offset:6144
    ds_read_b128 v[188:191], v6 offset:7168
    s_waitcnt lgkmcnt(7)
    v_add_f32 v192, v40, v160
    v_add_f32 v193, v41, v161
    v_add_f32 v194, v42, v162
    v_add_f32 v195, v43, v163
    buffer_store_dwordx4 v[192:195], v4, s[24:27], s49 offen offset:0 sc1
    s_waitcnt lgkmcnt(6)
    v_add_f32 v196, v44, v164
    v_add_f32 v197, v45, v165
    v_add_f32 v198, v46, v166
    v_add_f32 v199, v47, v167
    buffer_store_dwordx4 v[196:199], v4, s[24:27], s49 offen offset:1024 sc1
    s_waitcnt lgkmcnt(5)
    v_add_f32 v200, v56, v168
    v_add_f32 v201, v57, v169
    v_add_f32 v202, v58, v170
    v_add_f32 v203, v59, v171
    buffer_store_dwordx4 v[200:203], v4, s[24:27], s49 offen offset:2048 sc1
    s_waitcnt lgkmcnt(4)
    v_add_f32 v204, v60, v172
    v_add_f32 v205, v61, v173
    v_add_f32 v206, v62, v174
    v_add_f32 v207, v63, v175
    buffer_store_dwordx4 v[204:207], v4, s[24:27], s49 offen offset:3072 sc1
    s_waitcnt lgkmcnt(3)
    v_add_f32 v208, v72, v176
    v_add_f32 v209, v73, v177
    v_add_f32 v210, v74, v178
    v_add_f32 v211, v75, v179
    s_waitcnt lgkmcnt(2)
    v_add_f32 v212, v76, v180
    v_add_f32 v213, v77, v181
    v_add_f32 v214, v78, v182
    v_add_f32 v215, v79, v183
    s_waitcnt lgkmcnt(1)
    v_add_f32 v216, v88, v184
    v_add_f32 v217, v89, v185
    v_add_f32 v218, v90, v186
    v_add_f32 v219, v91, v187
    s_waitcnt lgkmcnt(0)
    v_add_f32 v220, v92, v188
    v_add_f32 v221, v93, v189
    v_add_f32 v222, v94, v190
    v_add_f32 v223, v95, v191
k2_common:
    v_lshlrev_b32 v160, 16, v248
    v_and_b32 v161, 0xffff0000, v248
    v_lshlrev_b32 v162, 16, v249
    v_and_b32 v163, 0xffff0000, v249
    v_lshlrev_b32 v164, 16, v250
    v_and_b32 v165, 0xffff0000, v250
    v_lshlrev_b32 v166, 16, v251
    v_and_b32 v167, 0xffff0000, v251
    v_lshlrev_b32 v230, 16, v240
    v_and_b32 v231, 0xffff0000, v240
    v_mul_f32 v230, v230, v160
    v_mul_f32 v231, v231, v161
    v_cvt_pk_bf16_f32 v230, v230, v231
    v_and_b32 v231, 0xffff0000, v230
    v_lshlrev_b32 v230, 16, v230
    v_fma_f32 v208, v230, v228, v208
    v_fma_f32 v209, v231, v228, v209
    v_lshlrev_b32 v230, 16, v241
    v_and_b32 v231, 0xffff0000, v241
    v_mul_f32 v230, v230, v162
    v_mul_f32 v231, v231, v163
    v_cvt_pk_bf16_f32 v230, v230, v231
    v_and_b32 v231, 0xffff0000, v230
    v_lshlrev_b32 v230, 16, v230
    v_fma_f32 v210, v230, v228, v210
    v_fma_f32 v211, v231, v228, v211
    v_lshlrev_b32 v230, 16, v242
    v_and_b32 v231, 0xffff0000, v242
    v_mul_f32 v230, v230, v160
    v_mul_f32 v231, v231, v161
    v_cvt_pk_bf16_f32 v230, v230, v231
    v_and_b32 v231, 0xffff0000, v230
    v_lshlrev_b32 v230, 16, v230
    v_fma_f32 v212, v230, v229, v212
    v_fma_f32 v213, v231, v229, v213
    v_lshlrev_b32 v230, 16, v243
    v_and_b32 v231, 0xffff0000, v243
    v_mul_f32 v230, v230, v162
    v_mul_f32 v231, v231, v163
    v_cvt_pk_bf16_f32 v230, v230, v231
    v_and_b32 v231, 0xffff0000, v230
    v_lshlrev_b32 v230, 16, v230
    v_fma_f32 v214, v230, v229, v214
    v_fma_f32 v215, v231, v229, v215
    v_lshlrev_b32 v230, 16, v244
    v_and_b32 v231, 0xffff0000, v244
    v_mul_f32 v230, v230, v164
    v_mul_f32 v231, v231, v165
    v_cvt_pk_bf16_f32 v230, v230, v231
    v_and_b32 v231, 0xffff0000, v230
    v_lshlrev_b32 v230, 16, v230
    v_fma_f32 v216, v230, v228, v216
    v_fma_f32 v217, v231, v228, v217
    v_lshlrev_b32 v230, 16, v245
    v_and_b32 v231, 0xffff0000, v245
    v_mul_f32 v230, v230, v166
    v_mul_f32 v231, v231, v167
    v_cvt_pk_bf16_f32 v230, v230, v231
    v_and_b32 v231, 0xffff0000, v230
    v_lshlrev_b32 v230, 16, v230
    v_fma_f32 v218, v230, v228, v218
    v_fma_f32 v219, v231, v228, v219
    v_lshlrev_b32 v230, 16, v246
    v_and_b32 v231, 0xffff0000, v246
    v_mul_f32 v230, v230, v164
    v_mul_f32 v231, v231, v165
    v_cvt_pk_bf16_f32 v230, v230, v231
    v_and_b32 v231, 0xffff0000, v230
    v_lshlrev_b32 v230, 16, v230
    v_fma_f32 v220, v230, v229, v220
    v_fma_f32 v221, v231, v229, v221
    v_lshlrev_b32 v230, 16, v247
    v_and_b32 v231, 0xffff0000, v247
    v_mul_f32 v230, v230, v166
    v_mul_f32 v231, v231, v167
    v_cvt_pk_bf16_f32 v230, v230, v231
    v_and_b32 v231, 0xffff0000, v230
    v_lshlrev_b32 v230, 16, v230
    v_fma_f32 v222, v230, v229, v222
    v_fma_f32 v223, v231, v229, v223
    s_xor_b32 s48, s49, 4194304
    s_lshl_b32 s50, s2, 10
    s_lshl_b32 s51, s3, 7
    s_add_u32 s50, s50, s51
    s_add_u32 s50, s50, 26214400
    s_xor_b32 s51, s50, 131072
    s_waitcnt vmcnt(0)
    s_barrier
    s_cmp_lg_u32 s3, 0
    s_cbranch_scc1 k2_join
    v_mov_b32 v6, s85
    s_mov_b64 exec, 1
    buffer_store_dword v6, v31, s[24:27], s50 offen sc1
    s_mov_b64 exec, -1
    s_mov_b32 s59, 400000
k2_poll:
    buffer_load_dword v7, v31, s[24:27], s51 offen sc1
    s_sub_u32 s59, s59, 1
    s_waitcnt vmcnt(0)
    v_readfirstlane_b32 s49, v7
    s_cmp_eq_u32 s49, s85
    s_cbranch_scc1 k2_join
    s_cmp_lg_u32 s59, 0
    s_cbranch_scc1 k2_poll
k2_join:
    s_barrier
    buffer_load_dwordx4 v[160:163], v4, s[24:27], s48 offen offset:0 sc1
    buffer_load_dwordx4 v[164:167], v4, s[24:27], s48 offen offset:1024 sc1
    buffer_load_dwordx4 v[168:171], v4, s[24:27], s48 offen offset:2048 sc1
    buffer_load_dwordx4 v[172:175], v4, s[24:27], s48 offen offset:3072 sc1
    v_lshlrev_b32 v5, 4, v3
    v_lshl_add_u32 v5, v2, 12, v5
    s_lshl_b32 s48, s78, 12
    s_lshl_b32 s49, s79, 2
    s_add_u32 s48, s48, s49
    s_add_u32 s49, s48, 65536
    s_waitcnt vmcnt(3)
    v_add_f32 v208, v208, v160
    v_add_f32 v209, v209, v161
    v_add_f32 v210, v210, v162
    v_add_f32 v211, v211, v163
    buffer_store_dwordx4 v[208:211], v5, s[68:71], s48 offen offset:0
    s_waitcnt vmcnt(3)
    v_add_f32 v212, v212, v164
    v_add_f32 v213, v213, v165
    v_add_f32 v214, v214, v166
    v_add_f32 v215, v215, v167
    buffer_store_dwordx4 v[212:215], v5, s[68:71], s49 offen offset:0
    s_waitcnt vmcnt(3)
    v_add_f32 v216, v216, v168
    v_add_f32 v217, v217, v169
    v_add_f32 v218, v218, v170
    v_add_f32 v219, v219, v171
    buffer_store_dwordx4 v[216:219], v5, s[68:71], s48 offen offset:64
    s_waitcnt vmcnt(3)
    v_add_f32 v220, v220, v172
    v_add_f32 v221, v221, v173
    v_add_f32 v222, v222, v174
    v_add_f32 v223, v223, v175
    buffer_store_dwordx4 v[220:223], v5, s[68:71], s49 offen offset:64
k1_end:
    s_endpgm
.section .rodata,"a"
.p2align 6
.amdhsa_kernel gated_mix__ssm_conv_s5__dense_activation_relu__prompt_kernel
  .amdhsa_next_free_vgpr 256
  .amdhsa_next_free_sgpr 102
  .amdhsa_accum_offset 256
  .amdhsa_group_segment_fixed_size 0
  .amdhsa_kernarg_size 128
  .amdhsa_user_sgpr_count 2
  .amdhsa_user_sgpr_kernarg_segment_ptr 1
  .amdhsa_system_sgpr_workgroup_id_x 1
.end_amdhsa_kernel
```
